```python
import torch

def _softmax(x, axis=-1):
    return torch.softmax(x, dim=axis)
def _gelu(x):
    return torch.nn.functional.gelu(x, approximate="tanh")
def _silu(x):
    return torch.nn.functional.silu(x)
def _sigmoid(x):
    return torch.sigmoid(x)
def _layernorm(x, axis=-1, eps=1e-5):
    m = x.mean(dim=axis, keepdim=True)
    v = x.var(dim=axis, keepdim=True, unbiased=False)
    return (x - m) / torch.sqrt(v + eps)
def _scatter_add(tgt, idx, src, axis=0):
    return tgt.clone().index_add_(axis, idx, src)
def _segment_sum(src, seg, n):
    out = torch.zeros((n,) + src.shape[1:], dtype=src.dtype)
    return out.index_add_(0, seg, src)
def _pad(x, pw):
    flat = tuple(v for pair in reversed(pw) for v in pair)
    return torch.nn.functional.pad(x, flat)

kernel_name = 'concat_heads__linear_kernel_hedgehog__mha_block__prompt'

def setup_inputs():

    _w = (lambda a: (lambda t: t.to(torch.bfloat16) if t.is_floating_point() else t)(torch.as_tensor(a)))
    def _A_setup():
        B, S, D, H = 1, 2048, 448, 16
        Dh = D // H
        return {
            "x": _w((lambda *s: torch.randn(*s, dtype=torch.bfloat16) * 0.8)(B, S, D)),
            "wqkv": _w((lambda *s: torch.randn(*s, dtype=torch.bfloat16) * 1.6)(D, 3 * D)),
            "w_phi": _w((lambda *s: torch.randn(*s, dtype=torch.bfloat16) * 1.6)(H, Dh, Dh) * (Dh ** -0.5)),
            "wo": _w((lambda *s: torch.randn(*s, dtype=torch.bfloat16) * 0.1)(D, D)),
        }
    _A_in = _A_setup()

    def _B_setup():
        B, S, D, H = 1, 2048, 448, 16
        return {
            "x": _w((lambda *s: torch.randn(*s, dtype=torch.bfloat16) * 0.4)(B, S, D)),
            "wqkv": _w((lambda *s: torch.randn(*s, dtype=torch.bfloat16) * 0.4)(D, 3 * D)),
            "wo": _w((lambda *s: torch.randn(*s, dtype=torch.bfloat16) * 0.05)(D, D)),
        }
    _B_in = _B_setup()

    return {
        "A_x": _A_in["x"],
        "A_wqkv": _A_in["wqkv"],
        "A_w_phi": _A_in["w_phi"],
        "A_wo": _A_in["wo"],
        "B_x": _B_in["x"],
        "B_wqkv": _B_in["wqkv"],
        "B_wo": _B_in["wo"],
    }

def reference(A_x, A_wqkv, A_w_phi, A_wo, B_x, B_wqkv, B_wo):
    def _A_ref(x, wqkv, w_phi, wo):
        B, S, D = x.shape
        H = 16; Dh = D // H
        qkv = (lambda x, *d: x.permute(*d))((x @ wqkv).reshape(B, S, 3, H, Dh), 2, 0, 3, 1, 4)
        q, k, v = qkv[0], qkv[1], qkv[2]
        pq = torch.einsum("bhsd,hdf->bhsf", q, w_phi)
        pk = torch.einsum("bhsd,hdf->bhsf", k, w_phi)
        phi_q = torch.concatenate([_softmax(pq, axis=-1), _softmax(-pq, axis=-1)], axis=-1)
        phi_k = torch.concatenate([_softmax(pk, axis=-1), _softmax(-pk, axis=-1)], axis=-1)
        kv = torch.einsum("bhsf,bhsd->bhfd", phi_k, v)
        z  = torch.einsum("bhsf->bhf", phi_k)
        num = torch.einsum("bhqf,bhfd->bhqd", phi_q, kv)
        den = torch.einsum("bhqf,bhf->bhq", phi_q, z)[..., None] + 1e-6
        o = num / den
        return (lambda x, *d: x.permute(*d))(o, 0, 2, 1, 3).reshape(B, S, D) @ wo

    def _B_ref(x, wqkv, wo):
        B, S, D = x.shape
        H = 16
        Dh = D // H
        qkv = (lambda x, *d: x.permute(*d))((x @ wqkv).reshape(B, S, 3, H, Dh), 2, 0, 3, 1, 4)
        q, k, v = qkv[0], qkv[1], qkv[2]
        scores = torch.einsum("bhqd,bhkd->bhqk", q, k) * (Dh ** -0.5)
        p = _softmax(scores, axis=-1)
        o = torch.einsum("bhqk,bhkd->bhqd", p, v)
        return (lambda x, *d: x.permute(*d))(o, 0, 2, 1, 3).reshape(B, S, D) @ wo

    a = _A_ref(A_x, A_wqkv, A_w_phi, A_wo)
    b = _B_ref(B_x, B_wqkv, B_wo)
    return torch.concatenate([a, b], axis=-1)
```

```asm
; @launch grid=(256,1,1) block=(512,1,1) lds=163840
.amdgcn_target "amdgcn-amd-amdhsa--gfx950"
.text
.globl concat_heads__linear_kernel_hedgehog__mha_block__prompt_kernel
.p2align 8
.type concat_heads__linear_kernel_hedgehog__mha_block__prompt_kernel,@function
concat_heads__linear_kernel_hedgehog__mha_block__prompt_kernel:
    s_cmp_ge_u32 s2, 256
    s_cbranch_scc1 concat_heads__linear_kernel_hedgehog__mha_block__prompt_kernel_end
    s_load_dwordx16 s[40:55], s[0:1], 0
    s_load_dwordx4 s[56:59], s[0:1], 64
    v_lshrrev_b32 v1, 6, v0
    s_and_b32 s24, s2, 7
    s_lshr_b32 s25, s2, 3
    v_readfirstlane_b32 s26, v1
    v_and_b32 v0, 63, v0
    s_lshr_b32 s27, s24, 2
    s_and_b32 s30, s24, 3
    s_lshl_b32 s30, s30, 2
    s_and_b32 s28, s25, 3
    s_add_u32 s28, s28, s30
    s_lshr_b32 s29, s25, 2
    s_mov_b32 s69, s2
    s_mul_i32 s67, s29, 336
    s_and_b32 s32, s67, 0xffffff80
    s_and_b32 s67, s67, 127
    s_add_u32 s33, s67, 463
    s_lshr_b32 s33, s33, 7
    s_cmp_lt_u32 s26, 4
    s_cbranch_scc1 concat_heads__linear_kernel_hedgehog__mha_block__prompt_kernel_p1c
    s_sub_u32 s60, s26, 4
    v_lshrrev_b32 v1, 3, v0
    v_and_b32 v3, 7, v0
    v_lshrrev_b32 v2, 4, v0
    v_mul_u32_u24 v5, 896, v1
    v_mul_u32_u24 v7, 2688, v1
    v_xor_b32 v4, v2, v3
    v_lshl_add_u32 v5, v4, 4, v5
    v_xor_b32 v4, 4, v4
    v_mul_u32_u24 v6, 896, v1
    v_lshl_add_u32 v6, v4, 4, v6
    v_and_b32 v2, 1, v2
    v_lshlrev_b32 v2, 2, v2
    v_xor_b32 v2, v2, v3
    v_lshl_add_u32 v7, v2, 4, v7
    s_lshl_b32 s30, s28, 2
    s_add_u32 s30, s30, s60
    s_mul_i32 s61, s30, 28672
    s_mul_i32 s62, s60, 21504
    s_add_u32 s62, s62, s32
    s_lshl_b32 s63, s60, 12
    s_lshl_b32 s64, s60, 10
    s_waitcnt lgkmcnt(0)
    s_cmp_eq_u32 s27, 0
    s_cselect_b32 s4, s40, s48
    s_cselect_b32 s5, s41, s49
    s_cselect_b32 s6, s42, s50
    s_cselect_b32 s7, s43, s51
    s_mov_b32 s12, s4
    s_mov_b32 s13, s5
    s_mov_b32 s14, 1835008
    s_mov_b32 s15, 0x00020000
    s_mov_b32 s16, s6
    s_mov_b32 s17, s7
    s_mov_b32 s18, 1204224
    s_mov_b32 s19, 0x00020000
    s_mov_b32 s8, s58
    s_mov_b32 s9, s59
    s_mov_b32 s10, 23068672
    s_mov_b32 s11, 0x00020000
    s_mov_b32 s20, s56
    s_mov_b32 s21, s57
    s_mov_b32 s22, 256
    s_mov_b32 s23, 0x00020000
    s_cmp_lt_u32 s2, 32
    s_cselect_b32 s30, s26, 0
    s_cmp_eq_u32 s30, 7
    s_cselect_b32 s39, 1, 0
    s_cbranch_scc0 concat_heads__linear_kernel_hedgehog__mha_block__prompt_kernel_nozero
    v_lshlrev_b32 v1, 4, v0
    v_mov_b32 v8, 0
    v_mov_b32 v9, 0
    v_mov_b32 v10, 0
    v_mov_b32 v11, 0
    s_mul_i32 s30, s2, 5120
    s_add_u32 s30, s30, 19398656
    buffer_store_dwordx4 v[8:11], v1, s[8:11], s30 offen sc1
    s_add_u32 s30, s30, 1024
    buffer_store_dwordx4 v[8:11], v1, s[8:11], s30 offen sc1
    s_add_u32 s30, s30, 1024
    buffer_store_dwordx4 v[8:11], v1, s[8:11], s30 offen sc1
    s_add_u32 s30, s30, 1024
    buffer_store_dwordx4 v[8:11], v1, s[8:11], s30 offen sc1
    s_add_u32 s30, s30, 1024
    buffer_store_dwordx4 v[8:11], v1, s[8:11], s30 offen sc1
    s_add_u32 s30, s30, 1024
    s_nop 0
concat_heads__linear_kernel_hedgehog__mha_block__prompt_kernel_nozero:
    s_cmp_eq_u32 s33, 3
    s_cbranch_scc1 concat_heads__linear_kernel_hedgehog__mha_block__prompt_kernel_ld3
concat_heads__linear_kernel_hedgehog__mha_block__prompt_kernel_ld4:
    s_barrier
    s_add_u32 s65, s61, 0
    s_add_u32 m0, s63, 0
    s_nop 0
    buffer_load_dwordx4 v5, s[12:15], s65 offen nt lds
    s_add_u32 m0, s63, 1024
    s_add_u32 s65, s65, 7168
    buffer_load_dwordx4 v6, s[12:15], s65 offen nt lds
    s_add_u32 m0, s63, 2048
    s_add_u32 s65, s65, 7168
    buffer_load_dwordx4 v5, s[12:15], s65 offen nt lds
    s_add_u32 m0, s63, 3072
    s_add_u32 s65, s65, 7168
    buffer_load_dwordx4 v6, s[12:15], s65 offen nt lds
    s_add_u32 m0, s64, 65536
    s_add_u32 s66, s62, 0
    buffer_load_dwordx4 v7, s[16:19], s66 offen  lds
    s_add_u32 m0, s64, 69632
    s_add_u32 s66, s62, 128
    buffer_load_dwordx4 v7, s[16:19], s66 offen  lds
    s_add_u32 m0, s64, 73728
    s_add_u32 s66, s62, 256
    buffer_load_dwordx4 v7, s[16:19], s66 offen  lds
    s_add_u32 m0, s64, 77824
    s_add_u32 s66, s62, 384
    buffer_load_dwordx4 v7, s[16:19], s66 offen  lds
    s_add_u32 m0, s64, 81920
    s_add_u32 s66, s62, 86016
    buffer_load_dwordx4 v7, s[16:19], s66 offen  lds
    s_add_u32 m0, s64, 86016
    s_add_u32 s66, s62, 86144
    buffer_load_dwordx4 v7, s[16:19], s66 offen  lds
    s_add_u32 m0, s64, 90112
    s_add_u32 s66, s62, 86272
    buffer_load_dwordx4 v7, s[16:19], s66 offen  lds
    s_add_u32 m0, s64, 94208
    s_add_u32 s66, s62, 86400
    buffer_load_dwordx4 v7, s[16:19], s66 offen  lds
    s_add_u32 s65, s61, 128
    s_add_u32 m0, s63, 16384
    s_nop 0
    buffer_load_dwordx4 v5, s[12:15], s65 offen nt lds
    s_add_u32 m0, s63, 17408
    s_add_u32 s65, s65, 7168
    buffer_load_dwordx4 v6, s[12:15], s65 offen nt lds
    s_add_u32 m0, s63, 18432
    s_add_u32 s65, s65, 7168
    buffer_load_dwordx4 v5, s[12:15], s65 offen nt lds
    s_add_u32 m0, s63, 19456
    s_add_u32 s65, s65, 7168
    buffer_load_dwordx4 v6, s[12:15], s65 offen nt lds
    s_add_u32 m0, s64, 98304
    s_add_u32 s66, s62, 172032
    buffer_load_dwordx4 v7, s[16:19], s66 offen  lds
    s_add_u32 m0, s64, 102400
    s_add_u32 s66, s62, 172160
    buffer_load_dwordx4 v7, s[16:19], s66 offen  lds
    s_add_u32 m0, s64, 106496
    s_add_u32 s66, s62, 172288
    buffer_load_dwordx4 v7, s[16:19], s66 offen  lds
    s_add_u32 m0, s64, 110592
    s_add_u32 s66, s62, 172416
    buffer_load_dwordx4 v7, s[16:19], s66 offen  lds
    s_add_u32 m0, s64, 114688
    s_add_u32 s66, s62, 258048
    buffer_load_dwordx4 v7, s[16:19], s66 offen  lds
    s_add_u32 m0, s64, 118784
    s_add_u32 s66, s62, 258176
    buffer_load_dwordx4 v7, s[16:19], s66 offen  lds
    s_add_u32 m0, s64, 122880
    s_add_u32 s66, s62, 258304
    buffer_load_dwordx4 v7, s[16:19], s66 offen  lds
    s_add_u32 m0, s64, 126976
    s_add_u32 s66, s62, 258432
    buffer_load_dwordx4 v7, s[16:19], s66 offen  lds
    s_add_u32 s65, s61, 256
    s_add_u32 m0, s63, 32768
    s_nop 0
    buffer_load_dwordx4 v5, s[12:15], s65 offen nt lds
    s_add_u32 m0, s63, 33792
    s_add_u32 s65, s65, 7168
    buffer_load_dwordx4 v6, s[12:15], s65 offen nt lds
    s_add_u32 m0, s63, 34816
    s_add_u32 s65, s65, 7168
    buffer_load_dwordx4 v5, s[12:15], s65 offen nt lds
    s_add_u32 m0, s63, 35840
    s_add_u32 s65, s65, 7168
    buffer_load_dwordx4 v6, s[12:15], s65 offen nt lds
    s_add_u32 m0, s64, 131072
    s_add_u32 s66, s62, 344064
    buffer_load_dwordx4 v7, s[16:19], s66 offen  lds
    s_add_u32 m0, s64, 135168
    s_add_u32 s66, s62, 344192
    buffer_load_dwordx4 v7, s[16:19], s66 offen  lds
    s_add_u32 m0, s64, 139264
    s_add_u32 s66, s62, 344320
    buffer_load_dwordx4 v7, s[16:19], s66 offen  lds
    s_add_u32 m0, s64, 143360
    s_add_u32 s66, s62, 344448
    buffer_load_dwordx4 v7, s[16:19], s66 offen  lds
    s_add_u32 m0, s64, 147456
    s_add_u32 s66, s62, 430080
    buffer_load_dwordx4 v7, s[16:19], s66 offen  lds
    s_add_u32 m0, s64, 151552
    s_add_u32 s66, s62, 430208
    buffer_load_dwordx4 v7, s[16:19], s66 offen  lds
    s_add_u32 m0, s64, 155648
    s_add_u32 s66, s62, 430336
    buffer_load_dwordx4 v7, s[16:19], s66 offen  lds
    s_add_u32 m0, s64, 159744
    s_add_u32 s66, s62, 430464
    buffer_load_dwordx4 v7, s[16:19], s66 offen  lds
    s_add_u32 s65, s61, 384
    s_add_u32 m0, s63, 49152
    s_nop 0
    buffer_load_dwordx4 v5, s[12:15], s65 offen nt lds
    s_add_u32 m0, s63, 50176
    s_add_u32 s65, s65, 7168
    buffer_load_dwordx4 v6, s[12:15], s65 offen nt lds
    s_add_u32 m0, s63, 51200
    s_add_u32 s65, s65, 7168
    buffer_load_dwordx4 v5, s[12:15], s65 offen nt lds
    s_add_u32 m0, s63, 52224
    s_add_u32 s65, s65, 7168
    buffer_load_dwordx4 v6, s[12:15], s65 offen nt lds
    s_lshl_b32 s30, s24, 1
    s_and_b32 s31, s25, 1
    s_add_u32 s37, s30, s31
    s_mov_b32 s4, s44
    s_mov_b32 s5, s45
    s_add_u32 s30, s37, 1
    s_mul_i32 s6, s30, 1568
    s_mov_b32 s7, 0x00020000
    s_mul_i32 s30, s37, 1568
    s_lshl_b32 s31, s60, 9
    v_lshl_add_u32 v16, v0, 3, s31
    buffer_load_dwordx2 v[14:15], v16, s[4:7], s30 offen
    s_waitcnt vmcnt(33)
    s_barrier
    s_cmp_eq_u32 s39, 1
    s_cbranch_scc0 concat_heads__linear_kernel_hedgehog__mha_block__prompt_kernel_ld4_nz
    s_mov_b32 s30, 0
    v_mov_b32 v1, 0
    v_mov_b32 v2, 1
    s_mov_b64 exec, 1
    buffer_atomic_add v2, v1, s[20:23], s30 offen
    s_mov_b64 exec, -1
concat_heads__linear_kernel_hedgehog__mha_block__prompt_kernel_ld4_nz:
    s_waitcnt vmcnt(29)
    s_barrier
    s_add_u32 m0, s64, 65536
    s_add_u32 s66, s62, 516096
    buffer_load_dwordx4 v7, s[16:19], s66 offen  lds
    s_add_u32 m0, s64, 69632
    s_add_u32 s66, s62, 516224
    buffer_load_dwordx4 v7, s[16:19], s66 offen  lds
    s_add_u32 m0, s64, 73728
    s_add_u32 s66, s62, 516352
    buffer_load_dwordx4 v7, s[16:19], s66 offen  lds
    s_add_u32 m0, s64, 77824
    s_add_u32 s66, s62, 516480
    buffer_load_dwordx4 v7, s[16:19], s66 offen  lds
    s_waitcnt vmcnt(25)
    s_barrier
    s_add_u32 m0, s64, 81920
    s_add_u32 s66, s62, 602112
    buffer_load_dwordx4 v7, s[16:19], s66 offen  lds
    s_add_u32 m0, s64, 86016
    s_add_u32 s66, s62, 602240
    buffer_load_dwordx4 v7, s[16:19], s66 offen  lds
    s_add_u32 m0, s64, 90112
    s_add_u32 s66, s62, 602368
    buffer_load_dwordx4 v7, s[16:19], s66 offen  lds
    s_add_u32 m0, s64, 94208
    s_add_u32 s66, s62, 602496
    buffer_load_dwordx4 v7, s[16:19], s66 offen  lds
    s_add_u32 s65, s61, 512
    s_add_u32 m0, s63, 0
    s_nop 0
    buffer_load_dwordx4 v5, s[12:15], s65 offen nt lds
    s_add_u32 m0, s63, 1024
    s_add_u32 s65, s65, 7168
    buffer_load_dwordx4 v6, s[12:15], s65 offen nt lds
    s_add_u32 m0, s63, 2048
    s_add_u32 s65, s65, 7168
    buffer_load_dwordx4 v5, s[12:15], s65 offen nt lds
    s_add_u32 m0, s63, 3072
    s_add_u32 s65, s65, 7168
    buffer_load_dwordx4 v6, s[12:15], s65 offen nt lds
    s_waitcnt vmcnt(29)
    s_barrier
    s_add_u32 m0, s64, 98304
    s_add_u32 s66, s62, 688128
    buffer_load_dwordx4 v7, s[16:19], s66 offen  lds
    s_add_u32 m0, s64, 102400
    s_add_u32 s66, s62, 688256
    buffer_load_dwordx4 v7, s[16:19], s66 offen  lds
    s_add_u32 m0, s64, 106496
    s_add_u32 s66, s62, 688384
    buffer_load_dwordx4 v7, s[16:19], s66 offen  lds
    s_add_u32 m0, s64, 110592
    s_add_u32 s66, s62, 688512
    buffer_load_dwordx4 v7, s[16:19], s66 offen  lds
    s_waitcnt vmcnt(25)
    s_barrier
    s_add_u32 m0, s64, 114688
    s_add_u32 s66, s62, 774144
    buffer_load_dwordx4 v7, s[16:19], s66 offen  lds
    s_add_u32 m0, s64, 118784
    s_add_u32 s66, s62, 774272
    buffer_load_dwordx4 v7, s[16:19], s66 offen  lds
    s_add_u32 m0, s64, 122880
    s_add_u32 s66, s62, 774400
    buffer_load_dwordx4 v7, s[16:19], s66 offen  lds
    s_add_u32 m0, s64, 126976
    s_add_u32 s66, s62, 774528
    buffer_load_dwordx4 v7, s[16:19], s66 offen  lds
    s_add_u32 s65, s61, 640
    s_add_u32 m0, s63, 16384
    s_nop 0
    buffer_load_dwordx4 v5, s[12:15], s65 offen nt lds
    s_add_u32 m0, s63, 17408
    s_add_u32 s65, s65, 7168
    buffer_load_dwordx4 v6, s[12:15], s65 offen nt lds
    s_add_u32 m0, s63, 18432
    s_add_u32 s65, s65, 7168
    buffer_load_dwordx4 v5, s[12:15], s65 offen nt lds
    s_add_u32 m0, s63, 19456
    s_add_u32 s65, s65, 7168
    buffer_load_dwordx4 v6, s[12:15], s65 offen nt lds
    s_waitcnt vmcnt(29)
    s_barrier
    s_add_u32 m0, s64, 131072
    s_add_u32 s66, s62, 860160
    buffer_load_dwordx4 v7, s[16:19], s66 offen  lds
    s_add_u32 m0, s64, 135168
    s_add_u32 s66, s62, 860288
    buffer_load_dwordx4 v7, s[16:19], s66 offen  lds
    s_add_u32 m0, s64, 139264
    s_add_u32 s66, s62, 860416
    buffer_load_dwordx4 v7, s[16:19], s66 offen  lds
    s_add_u32 m0, s64, 143360
    s_add_u32 s66, s62, 860544
    buffer_load_dwordx4 v7, s[16:19], s66 offen  lds
    s_waitcnt vmcnt(24)
    s_barrier
    s_add_u32 m0, s64, 147456
    s_add_u32 s66, s62, 946176
    buffer_load_dwordx4 v7, s[16:19], s66 offen  lds
    s_add_u32 m0, s64, 151552
    s_add_u32 s66, s62, 946304
    buffer_load_dwordx4 v7, s[16:19], s66 offen  lds
    s_add_u32 m0, s64, 155648
    s_add_u32 s66, s62, 946432
    buffer_load_dwordx4 v7, s[16:19], s66 offen  lds
    s_add_u32 m0, s64, 159744
    s_add_u32 s66, s62, 946560
    buffer_load_dwordx4 v7, s[16:19], s66 offen  lds
    s_add_u32 s65, s61, 768
    s_add_u32 m0, s63, 32768
    s_nop 0
    buffer_load_dwordx4 v5, s[12:15], s65 offen nt lds
    s_add_u32 m0, s63, 33792
    s_add_u32 s65, s65, 7168
    buffer_load_dwordx4 v6, s[12:15], s65 offen nt lds
    s_add_u32 m0, s63, 34816
    s_add_u32 s65, s65, 7168
    buffer_load_dwordx4 v5, s[12:15], s65 offen nt lds
    s_add_u32 m0, s63, 35840
    s_add_u32 s65, s65, 7168
    buffer_load_dwordx4 v6, s[12:15], s65 offen nt lds
    s_waitcnt vmcnt(28)
    s_barrier
    s_add_u32 m0, s64, 65536
    s_add_u32 s66, s62, 1032192
    buffer_load_dwordx4 v7, s[16:19], s66 offen  lds
    s_add_u32 m0, s64, 69632
    s_add_u32 s66, s62, 1032320
    buffer_load_dwordx4 v7, s[16:19], s66 offen  lds
    s_add_u32 m0, s64, 73728
    s_add_u32 s66, s62, 1032448
    buffer_load_dwordx4 v7, s[16:19], s66 offen  lds
    s_add_u32 m0, s64, 77824
    s_add_u32 s66, s62, 1032576
    buffer_load_dwordx4 v7, s[16:19], s66 offen  lds
    s_waitcnt vmcnt(24)
    s_barrier
    s_add_u32 m0, s64, 81920
    s_add_u32 s66, s62, 1118208
    buffer_load_dwordx4 v7, s[16:19], s66 offen  lds
    s_add_u32 m0, s64, 86016
    s_add_u32 s66, s62, 1118336
    buffer_load_dwordx4 v7, s[16:19], s66 offen  lds
    s_add_u32 m0, s64, 90112
    s_add_u32 s66, s62, 1118464
    buffer_load_dwordx4 v7, s[16:19], s66 offen  lds
    s_add_u32 m0, s64, 94208
    s_add_u32 s66, s62, 1118592
    buffer_load_dwordx4 v7, s[16:19], s66 offen  lds
    s_waitcnt vmcnt(24)
    s_barrier
    s_cmp_eq_u32 s27, 0
    s_cselect_b32 s4, s46, s52
    s_cselect_b32 s5, s47, s53
    s_mov_b32 s6, 401408
    s_mov_b32 s7, 0x00020000
    s_and_b32 s30, s25, 3
    s_mul_i32 s30, s30, 112
    s_lshl_b32 s31, s60, 6
    s_add_u32 s30, s30, s31
    s_mul_i32 s30, s30, 896
    s_lshl_b32 s31, s29, 7
    s_add_u32 s30, s30, s31
    s_cmp_lt_u32 s60, 2
    s_cselect_b32 s30, s30, 0x40000000
    s_cmp_lt_u32 s25, 28
    s_cselect_b32 s30, s30, 0x40000000
    v_mul_u32_u24 v12, 896, v0
    buffer_load_dword v13, v12, s[4:7], s30 offen
    s_waitcnt vmcnt(17)
    s_barrier
    s_waitcnt vmcnt(13)
    s_barrier
    s_waitcnt vmcnt(1)
    s_barrier
    s_branch concat_heads__linear_kernel_hedgehog__mha_block__prompt_kernel_p1_end
concat_heads__linear_kernel_hedgehog__mha_block__prompt_kernel_ld3:
    s_barrier
    s_add_u32 s65, s61, 0
    s_add_u32 m0, s63, 0
    s_nop 0
    buffer_load_dwordx4 v5, s[12:15], s65 offen nt lds
    s_add_u32 m0, s63, 1024
    s_add_u32 s65, s65, 7168
    buffer_load_dwordx4 v6, s[12:15], s65 offen nt lds
    s_add_u32 m0, s63, 2048
    s_add_u32 s65, s65, 7168
    buffer_load_dwordx4 v5, s[12:15], s65 offen nt lds
    s_add_u32 m0, s63, 3072
    s_add_u32 s65, s65, 7168
    buffer_load_dwordx4 v6, s[12:15], s65 offen nt lds
    s_add_u32 m0, s64, 65536
    s_add_u32 s66, s62, 0
    buffer_load_dwordx4 v7, s[16:19], s66 offen  lds
    s_add_u32 m0, s64, 69632
    s_add_u32 s66, s62, 128
    buffer_load_dwordx4 v7, s[16:19], s66 offen  lds
    s_add_u32 m0, s64, 73728
    s_add_u32 s66, s62, 256
    buffer_load_dwordx4 v7, s[16:19], s66 offen  lds
    s_add_u32 m0, s64, 81920
    s_add_u32 s66, s62, 86016
    buffer_load_dwordx4 v7, s[16:19], s66 offen  lds
    s_add_u32 m0, s64, 86016
    s_add_u32 s66, s62, 86144
    buffer_load_dwordx4 v7, s[16:19], s66 offen  lds
    s_add_u32 m0, s64, 90112
    s_add_u32 s66, s62, 86272
    buffer_load_dwordx4 v7, s[16:19], s66 offen  lds
    s_add_u32 s65, s61, 128
    s_add_u32 m0, s63, 16384
    s_nop 0
    buffer_load_dwordx4 v5, s[12:15], s65 offen nt lds
    s_add_u32 m0, s63, 17408
    s_add_u32 s65, s65, 7168
    buffer_load_dwordx4 v6, s[12:15], s65 offen nt lds
    s_add_u32 m0, s63, 18432
    s_add_u32 s65, s65, 7168
    buffer_load_dwordx4 v5, s[12:15], s65 offen nt lds
    s_add_u32 m0, s63, 19456
    s_add_u32 s65, s65, 7168
    buffer_load_dwordx4 v6, s[12:15], s65 offen nt lds
    s_add_u32 m0, s64, 98304
    s_add_u32 s66, s62, 172032
    buffer_load_dwordx4 v7, s[16:19], s66 offen  lds
    s_add_u32 m0, s64, 102400
    s_add_u32 s66, s62, 172160
    buffer_load_dwordx4 v7, s[16:19], s66 offen  lds
    s_add_u32 m0, s64, 106496
    s_add_u32 s66, s62, 172288
    buffer_load_dwordx4 v7, s[16:19], s66 offen  lds
    s_add_u32 m0, s64, 114688
    s_add_u32 s66, s62, 258048
    buffer_load_dwordx4 v7, s[16:19], s66 offen  lds
    s_add_u32 m0, s64, 118784
    s_add_u32 s66, s62, 258176
    buffer_load_dwordx4 v7, s[16:19], s66 offen  lds
    s_add_u32 m0, s64, 122880
    s_add_u32 s66, s62, 258304
    buffer_load_dwordx4 v7, s[16:19], s66 offen  lds
    s_add_u32 s65, s61, 256
    s_add_u32 m0, s63, 32768
    s_nop 0
    buffer_load_dwordx4 v5, s[12:15], s65 offen nt lds
    s_add_u32 m0, s63, 33792
    s_add_u32 s65, s65, 7168
    buffer_load_dwordx4 v6, s[12:15], s65 offen nt lds
    s_add_u32 m0, s63, 34816
    s_add_u32 s65, s65, 7168
    buffer_load_dwordx4 v5, s[12:15], s65 offen nt lds
    s_add_u32 m0, s63, 35840
    s_add_u32 s65, s65, 7168
    buffer_load_dwordx4 v6, s[12:15], s65 offen nt lds
    s_add_u32 m0, s64, 131072
    s_add_u32 s66, s62, 344064
    buffer_load_dwordx4 v7, s[16:19], s66 offen  lds
    s_add_u32 m0, s64, 135168
    s_add_u32 s66, s62, 344192
    buffer_load_dwordx4 v7, s[16:19], s66 offen  lds
    s_add_u32 m0, s64, 139264
    s_add_u32 s66, s62, 344320
    buffer_load_dwordx4 v7, s[16:19], s66 offen  lds
    s_add_u32 m0, s64, 147456
    s_add_u32 s66, s62, 430080
    buffer_load_dwordx4 v7, s[16:19], s66 offen  lds
    s_add_u32 m0, s64, 151552
    s_add_u32 s66, s62, 430208
    buffer_load_dwordx4 v7, s[16:19], s66 offen  lds
    s_add_u32 m0, s64, 155648
    s_add_u32 s66, s62, 430336
    buffer_load_dwordx4 v7, s[16:19], s66 offen  lds
    s_add_u32 s65, s61, 384
    s_add_u32 m0, s63, 49152
    s_nop 0
    buffer_load_dwordx4 v5, s[12:15], s65 offen nt lds
    s_add_u32 m0, s63, 50176
    s_add_u32 s65, s65, 7168
    buffer_load_dwordx4 v6, s[12:15], s65 offen nt lds
    s_add_u32 m0, s63, 51200
    s_add_u32 s65, s65, 7168
    buffer_load_dwordx4 v5, s[12:15], s65 offen nt lds
    s_add_u32 m0, s63, 52224
    s_add_u32 s65, s65, 7168
    buffer_load_dwordx4 v6, s[12:15], s65 offen nt lds
    s_lshl_b32 s30, s24, 1
    s_and_b32 s31, s25, 1
    s_add_u32 s37, s30, s31
    s_mov_b32 s4, s44
    s_mov_b32 s5, s45
    s_add_u32 s30, s37, 1
    s_mul_i32 s6, s30, 1568
    s_mov_b32 s7, 0x00020000
    s_mul_i32 s30, s37, 1568
    s_lshl_b32 s31, s60, 9
    v_lshl_add_u32 v16, v0, 3, s31
    buffer_load_dwordx2 v[14:15], v16, s[4:7], s30 offen
    s_waitcnt vmcnt(28)
    s_barrier
    s_cmp_eq_u32 s39, 1
    s_cbranch_scc0 concat_heads__linear_kernel_hedgehog__mha_block__prompt_kernel_ld3_nz
    s_mov_b32 s30, 0
    v_mov_b32 v1, 0
    v_mov_b32 v2, 1
    s_mov_b64 exec, 1
    buffer_atomic_add v2, v1, s[20:23], s30 offen
    s_mov_b64 exec, -1
concat_heads__linear_kernel_hedgehog__mha_block__prompt_kernel_ld3_nz:
    s_waitcnt vmcnt(25)
    s_barrier
    s_add_u32 m0, s64, 65536
    s_add_u32 s66, s62, 516096
    buffer_load_dwordx4 v7, s[16:19], s66 offen  lds
    s_add_u32 m0, s64, 69632
    s_add_u32 s66, s62, 516224
    buffer_load_dwordx4 v7, s[16:19], s66 offen  lds
    s_add_u32 m0, s64, 73728
    s_add_u32 s66, s62, 516352
    buffer_load_dwordx4 v7, s[16:19], s66 offen  lds
    s_waitcnt vmcnt(21)
    s_barrier
    s_add_u32 m0, s64, 81920
    s_add_u32 s66, s62, 602112
    buffer_load_dwordx4 v7, s[16:19], s66 offen  lds
    s_add_u32 m0, s64, 86016
    s_add_u32 s66, s62, 602240
    buffer_load_dwordx4 v7, s[16:19], s66 offen  lds
    s_add_u32 m0, s64, 90112
    s_add_u32 s66, s62, 602368
    buffer_load_dwordx4 v7, s[16:19], s66 offen  lds
    s_add_u32 s65, s61, 512
    s_add_u32 m0, s63, 0
    s_nop 0
    buffer_load_dwordx4 v5, s[12:15], s65 offen nt lds
    s_add_u32 m0, s63, 1024
    s_add_u32 s65, s65, 7168
    buffer_load_dwordx4 v6, s[12:15], s65 offen nt lds
    s_add_u32 m0, s63, 2048
    s_add_u32 s65, s65, 7168
    buffer_load_dwordx4 v5, s[12:15], s65 offen nt lds
    s_add_u32 m0, s63, 3072
    s_add_u32 s65, s65, 7168
    buffer_load_dwordx4 v6, s[12:15], s65 offen nt lds
    s_waitcnt vmcnt(25)
    s_barrier
    s_add_u32 m0, s64, 98304
    s_add_u32 s66, s62, 688128
    buffer_load_dwordx4 v7, s[16:19], s66 offen  lds
    s_add_u32 m0, s64, 102400
    s_add_u32 s66, s62, 688256
    buffer_load_dwordx4 v7, s[16:19], s66 offen  lds
    s_add_u32 m0, s64, 106496
    s_add_u32 s66, s62, 688384
    buffer_load_dwordx4 v7, s[16:19], s66 offen  lds
    s_waitcnt vmcnt(21)
    s_barrier
    s_add_u32 m0, s64, 114688
    s_add_u32 s66, s62, 774144
    buffer_load_dwordx4 v7, s[16:19], s66 offen  lds
    s_add_u32 m0, s64, 118784
    s_add_u32 s66, s62, 774272
    buffer_load_dwordx4 v7, s[16:19], s66 offen  lds
    s_add_u32 m0, s64, 122880
    s_add_u32 s66, s62, 774400
    buffer_load_dwordx4 v7, s[16:19], s66 offen  lds
    s_add_u32 s65, s61, 640
    s_add_u32 m0, s63, 16384
    s_nop 0
    buffer_load_dwordx4 v5, s[12:15], s65 offen nt lds
    s_add_u32 m0, s63, 17408
    s_add_u32 s65, s65, 7168
    buffer_load_dwordx4 v6, s[12:15], s65 offen nt lds
    s_add_u32 m0, s63, 18432
    s_add_u32 s65, s65, 7168
    buffer_load_dwordx4 v5, s[12:15], s65 offen nt lds
    s_add_u32 m0, s63, 19456
    s_add_u32 s65, s65, 7168
    buffer_load_dwordx4 v6, s[12:15], s65 offen nt lds
    s_waitcnt vmcnt(25)
    s_barrier
    s_add_u32 m0, s64, 131072
    s_add_u32 s66, s62, 860160
    buffer_load_dwordx4 v7, s[16:19], s66 offen  lds
    s_add_u32 m0, s64, 135168
    s_add_u32 s66, s62, 860288
    buffer_load_dwordx4 v7, s[16:19], s66 offen  lds
    s_add_u32 m0, s64, 139264
    s_add_u32 s66, s62, 860416
    buffer_load_dwordx4 v7, s[16:19], s66 offen  lds
    s_waitcnt vmcnt(20)
    s_barrier
    s_add_u32 m0, s64, 147456
    s_add_u32 s66, s62, 946176
    buffer_load_dwordx4 v7, s[16:19], s66 offen  lds
    s_add_u32 m0, s64, 151552
    s_add_u32 s66, s62, 946304
    buffer_load_dwordx4 v7, s[16:19], s66 offen  lds
    s_add_u32 m0, s64, 155648
    s_add_u32 s66, s62, 946432
    buffer_load_dwordx4 v7, s[16:19], s66 offen  lds
    s_add_u32 s65, s61, 768
    s_add_u32 m0, s63, 32768
    s_nop 0
    buffer_load_dwordx4 v5, s[12:15], s65 offen nt lds
    s_add_u32 m0, s63, 33792
    s_add_u32 s65, s65, 7168
    buffer_load_dwordx4 v6, s[12:15], s65 offen nt lds
    s_add_u32 m0, s63, 34816
    s_add_u32 s65, s65, 7168
    buffer_load_dwordx4 v5, s[12:15], s65 offen nt lds
    s_add_u32 m0, s63, 35840
    s_add_u32 s65, s65, 7168
    buffer_load_dwordx4 v6, s[12:15], s65 offen nt lds
    s_waitcnt vmcnt(24)
    s_barrier
    s_add_u32 m0, s64, 65536
    s_add_u32 s66, s62, 1032192
    buffer_load_dwordx4 v7, s[16:19], s66 offen  lds
    s_add_u32 m0, s64, 69632
    s_add_u32 s66, s62, 1032320
    buffer_load_dwordx4 v7, s[16:19], s66 offen  lds
    s_add_u32 m0, s64, 73728
    s_add_u32 s66, s62, 1032448
    buffer_load_dwordx4 v7, s[16:19], s66 offen  lds
    s_waitcnt vmcnt(20)
    s_barrier
    s_add_u32 m0, s64, 81920
    s_add_u32 s66, s62, 1118208
    buffer_load_dwordx4 v7, s[16:19], s66 offen  lds
    s_add_u32 m0, s64, 86016
    s_add_u32 s66, s62, 1118336
    buffer_load_dwordx4 v7, s[16:19], s66 offen  lds
    s_add_u32 m0, s64, 90112
    s_add_u32 s66, s62, 1118464
    buffer_load_dwordx4 v7, s[16:19], s66 offen  lds
    s_waitcnt vmcnt(20)
    s_barrier
    s_cmp_eq_u32 s27, 0
    s_cselect_b32 s4, s46, s52
    s_cselect_b32 s5, s47, s53
    s_mov_b32 s6, 401408
    s_mov_b32 s7, 0x00020000
    s_and_b32 s30, s25, 3
    s_mul_i32 s30, s30, 112
    s_lshl_b32 s31, s60, 6
    s_add_u32 s30, s30, s31
    s_mul_i32 s30, s30, 896
    s_lshl_b32 s31, s29, 7
    s_add_u32 s30, s30, s31
    s_cmp_lt_u32 s60, 2
    s_cselect_b32 s30, s30, 0x40000000
    s_cmp_lt_u32 s25, 28
    s_cselect_b32 s30, s30, 0x40000000
    v_mul_u32_u24 v12, 896, v0
    buffer_load_dword v13, v12, s[4:7], s30 offen
    s_waitcnt vmcnt(14)
    s_barrier
    s_waitcnt vmcnt(11)
    s_barrier
    s_waitcnt vmcnt(1)
    s_barrier
    s_branch concat_heads__linear_kernel_hedgehog__mha_block__prompt_kernel_p1_end
concat_heads__linear_kernel_hedgehog__mha_block__prompt_kernel_p1c:
    s_and_b32 s60, s26, 1
    s_lshr_b32 s61, s26, 1
    s_lshl_b32 s62, s29, 1
    s_add_u32 s62, s62, s61
    s_lshl_b32 s30, s60, 13
    v_and_b32 v1, 31, v0
    v_lshlrev_b32 v1, 7, v1
    v_add_u32 v1, s30, v1
    v_lshrrev_b32 v2, 5, v0
    v_bfe_u32 v3, v0, 1, 3
    v_xor_b32 v2, v2, v3
    v_lshl_add_u32 v17, v2, 4, v1
    v_xor_b32 v18, 32, v17
    v_xor_b32 v19, 64, v17
    v_xor_b32 v20, 96, v17
    v_lshlrev_b32 v27, 4, v0
    v_lshrrev_b32 v1, 5, v0
    v_lshlrev_b32 v1, 3, v1
    v_bfe_u32 v2, v0, 2, 2
    v_add_u32 v1, v1, v2
    v_lshlrev_b32 v1, 7, v1
    v_bfe_u32 v2, v0, 4, 1
    v_lshlrev_b32 v2, 5, v2
    v_and_b32 v3, 3, v0
    v_lshl_add_u32 v2, v3, 3, v2
    v_bfe_u32 v3, v0, 3, 1
    v_lshlrev_b32 v3, 6, v3
    s_mul_i32 s30, s61, 168
    s_add_u32 s30, s30, s67
    s_add_u32 s31, s30, 0
    v_add_u32 v4, s31, v2
    v_lshrrev_b32 v21, 7, v4
    v_lshlrev_b32 v21, 12, v21
    v_and_b32 v4, 127, v4
    v_xor_b32 v4, v4, v3
    v_add3_u32 v21, v21, v4, v1
    v_add_u32 v21, 65536, v21
    v_add_u32 v24, 65536, v21
    s_add_u32 s31, s30, 56
    v_add_u32 v4, s31, v2
    v_lshrrev_b32 v22, 7, v4
    v_lshlrev_b32 v22, 12, v22
    v_and_b32 v4, 127, v4
    v_xor_b32 v4, v4, v3
    v_add3_u32 v22, v22, v4, v1
    v_add_u32 v22, 65536, v22
    v_add_u32 v25, 65536, v22
    s_add_u32 s31, s30, 112
    v_add_u32 v4, s31, v2
    v_lshrrev_b32 v23, 7, v4
    v_lshlrev_b32 v23, 12, v23
    v_and_b32 v4, 127, v4
    v_xor_b32 v4, v4, v3
    v_add3_u32 v23, v23, v4, v1
    v_add_u32 v23, 65536, v23
    v_add_u32 v26, 65536, v23
    s_waitcnt lgkmcnt(0)
    s_mov_b32 s8, s58
    s_mov_b32 s9, s59
    s_mov_b32 s10, 23068672
    s_mov_b32 s11, 0x00020000
    s_mov_b32 s20, s56
    s_mov_b32 s21, s57
    s_mov_b32 s22, 256
    s_mov_b32 s23, 0x00020000
    s_mul_i32 s63, s27, 6291456
    s_mul_i32 s30, s62, 393216
    s_add_u32 s63, s63, s30
    s_lshl_b32 s30, s28, 13
    s_add_u32 s63, s63, s30
    s_lshl_b32 s30, s60, 12
    s_add_u32 s63, s63, s30
    s_mov_b32 s34, 0
    s_mov_b32 s35, -1
    s_getpc_b64 s[4:5]
concat_heads__linear_kernel_hedgehog__mha_block__prompt_kernel_pc:
    s_lshl_b32 s30, s25, 4
    v_and_b32 v1, 15, v0
    v_add_u32 v1, s30, v1
    v_lshlrev_b32 v1, 7, v1
    v_min_u32 v1, concat_heads__linear_kernel_hedgehog__mha_block__prompt_kernel_end-concat_heads__linear_kernel_hedgehog__mha_block__prompt_kernel_pc-4, v1
    v_and_b32 v1, 0xfffffffc, v1
    v_mov_b32 v29, s5
    v_add_co_u32 v28, vcc, s4, v1
    s_nop 1
    v_addc_co_u32 v29, vcc, 0, v29, vcc
    global_load_dword v30, v[28:29], off
    s_cmp_eq_u32 s27, 0
    s_cselect_b32 s4, s40, s48
    s_cselect_b32 s5, s41, s49
    s_cselect_b32 s6, s42, s50
    s_cselect_b32 s7, s43, s51
    s_mov_b32 s12, s4
    s_mov_b32 s13, s5
    s_mov_b32 s14, 1835008
    s_mov_b32 s15, 0x00020000
    s_mov_b32 s16, s6
    s_mov_b32 s17, s7
    s_mov_b32 s18, 1204224
    s_mov_b32 s19, 0x00020000
    v_lshrrev_b32 v1, 2, v0
    v_lshrrev_b32 v2, 3, v1
    v_and_b32 v1, 7, v1
    v_lshl_add_u32 v1, v2, 5, v1
    s_and_b32 s30, s25, 3
    s_lshl_b32 s30, s30, 3
    v_add_u32 v1, s30, v1
    v_mul_u32_u24 v1, 2688, v1
    v_and_b32 v2, 3, v0
    v_lshl_add_u32 v31, v2, 7, v1
    v_mov_b32 v3, 0x40000000
    v_cmp_gt_u32 vcc, s33, v2
    s_nop 1
    v_cndmask_b32 v31, v3, v31, vcc
    s_mul_i32 s31, s29, 336
    s_and_b32 s31, s31, 0xffffff80
    s_mul_i32 s30, s26, 172032
    s_add_u32 s31, s31, s30
    s_lshl_b32 s30, s28, 7
    s_lshl_b32 s32, s29, 4
    s_add_u32 s30, s30, s32
    s_mul_i32 s30, s30, 896
    v_and_b32 v1, 15, v0
    v_mul_u32_u24 v1, 896, v1
    v_lshrrev_b32 v2, 4, v0
    v_lshl_add_u32 v32, v2, 7, v1
    s_cmp_eq_u32 s26, 0
    s_cselect_b32 s32, s30, 0x40000000
    buffer_load_dword v34, v32, s[12:15], s32 offen
    buffer_load_dword v34, v31, s[16:19], s31 offen
    s_add_u32 s30, s30, 512
    s_cmp_eq_u32 s26, 1
    s_cselect_b32 s32, s30, 0x40000000
    s_mov_b32 exec_hi, 0xffff
    buffer_load_dword v34, v32, s[12:15], s32 offen
    s_mov_b64 exec, -1
    s_add_u32 s31, s31, 688128
    s_cmp_lt_u32 s26, 3
    s_cselect_b32 s31, s31, 0x40000000
    buffer_load_dword v34, v31, s[16:19], s31 offen
    s_waitcnt vmcnt(3)
    s_barrier
    v_and_b32 v1, 31, v0
    v_cmp_eq_u32 vcc, 28, v1
    v_mov_b32 v2, 1065369472
    s_nop 0
    v_cndmask_b32 v35, 0, v2, vcc
    s_cmp_eq_u32 s62, 10
    s_cbranch_scc1 concat_heads__linear_kernel_hedgehog__mha_block__prompt_kernel_TTN
    s_cmp_gt_u32 s62, 10
    s_cbranch_scc1 concat_heads__linear_kernel_hedgehog__mha_block__prompt_kernel_NNN
concat_heads__linear_kernel_hedgehog__mha_block__prompt_kernel_TTT:
    s_add_u32 s66, s63, 0
    s_mul_i32 s30, s62, 3
    s_add_u32 s30, s30, 0
    s_cmp_lt_u32 s30, 16
    s_cselect_b32 s30, s27, 0
    s_cmp_eq_u32 s30, 1
    s_cselect_b32 s4, 0x3e8b97f6, 1.0
    s_mov_b32 s5, s4
    s_add_u32 s67, s63, 131072
    s_mul_i32 s30, s62, 3
    s_add_u32 s30, s30, 1
    s_cmp_lt_u32 s30, 16
    s_cselect_b32 s30, s27, 0
    s_cmp_eq_u32 s30, 1
    s_cselect_b32 s6, 0x3e8b97f6, 1.0
    s_mov_b32 s7, s6
    s_add_u32 s33, s63, 262144
    s_mul_i32 s30, s62, 3
    s_add_u32 s30, s30, 2
    s_cmp_lt_u32 s30, 16
    s_cselect_b32 s30, s27, 0
    s_cmp_eq_u32 s30, 1
    s_cselect_b32 s64, 0x3e8b97f6, 1.0
    s_mov_b32 s65, s64
    s_barrier
    ds_read_b128 v[136:139], v17 offset:0
    ds_read_b64_tr_b16 v[152:153], v21 offset:0
    ds_read_b64_tr_b16 v[154:155], v21 offset:512
    ds_read_b64_tr_b16 v[156:157], v22 offset:0
    ds_read_b64_tr_b16 v[158:159], v22 offset:512
    ds_read_b128 v[140:143], v17 offset:4096
    ds_read_b64_tr_b16 v[160:161], v23 offset:0
    ds_read_b64_tr_b16 v[162:163], v23 offset:512
    s_waitcnt lgkmcnt(5)
    v_mfma_f32_32x32x16_bf16 v[40:55], v[152:155], v[136:139], 0
    ds_read_b128 v[144:147], v18 offset:0
    ds_read_b64_tr_b16 v[164:165], v21 offset:2048
    s_waitcnt lgkmcnt(5)
    v_mfma_f32_32x32x16_bf16 v[56:71], v[156:159], v[136:139], 0
    ds_read_b64_tr_b16 v[166:167], v21 offset:2560
    ds_read_b64_tr_b16 v[168:169], v22 offset:2048
    s_waitcnt lgkmcnt(6)
    v_mfma_f32_32x32x16_bf16 v[88:103], v[152:155], v[140:143], 0
    ds_read_b64_tr_b16 v[170:171], v22 offset:2560
    ds_read_b128 v[148:151], v18 offset:4096
    v_mfma_f32_32x32x16_bf16 v[104:119], v[156:159], v[140:143], 0
    ds_read_b64_tr_b16 v[172:173], v23 offset:2048
    ds_read_b64_tr_b16 v[174:175], v23 offset:2560
    s_waitcnt lgkmcnt(8)
    v_mfma_f32_32x32x16_bf16 v[72:87], v[160:163], v[136:139], 0
    v_mfma_f32_32x32x16_bf16 v[120:135], v[160:163], v[140:143], 0
    s_waitcnt lgkmcnt(0)
    s_barrier
    v_mfma_f32_32x32x16_bf16 v[40:55], v[164:167], v[144:147], v[40:55]
    ds_read_b128 v[136:139], v19 offset:0
    ds_read_b64_tr_b16 v[152:153], v21 offset:16384
    v_mfma_f32_32x32x16_bf16 v[56:71], v[168:171], v[144:147], v[56:71]
    ds_read_b64_tr_b16 v[154:155], v21 offset:16896
    ds_read_b64_tr_b16 v[156:157], v22 offset:16384
    v_mfma_f32_32x32x16_bf16 v[88:103], v[164:167], v[148:151], v[88:103]
    ds_read_b64_tr_b16 v[158:159], v22 offset:16896
    ds_read_b128 v[140:143], v19 offset:4096
    v_mfma_f32_32x32x16_bf16 v[104:119], v[168:171], v[148:151], v[104:119]
    ds_read_b64_tr_b16 v[160:161], v23 offset:16384
    ds_read_b64_tr_b16 v[162:163], v23 offset:16896
    v_mfma_f32_32x32x16_bf16 v[72:87], v[172:175], v[144:147], v[72:87]
    v_mfma_f32_32x32x16_bf16 v[120:135], v[172:175], v[148:151], v[120:135]
    s_waitcnt lgkmcnt(5)
    v_mfma_f32_32x32x16_bf16 v[40:55], v[152:155], v[136:139], v[40:55]
    ds_read_b128 v[144:147], v20 offset:0
    ds_read_b64_tr_b16 v[164:165], v21 offset:18432
    s_waitcnt lgkmcnt(5)
    v_mfma_f32_32x32x16_bf16 v[56:71], v[156:159], v[136:139], v[56:71]
    ds_read_b64_tr_b16 v[166:167], v21 offset:18944
    ds_read_b64_tr_b16 v[168:169], v22 offset:18432
    s_waitcnt lgkmcnt(6)
    v_mfma_f32_32x32x16_bf16 v[88:103], v[152:155], v[140:143], v[88:103]
    ds_read_b64_tr_b16 v[170:171], v22 offset:18944
    ds_read_b128 v[148:151], v20 offset:4096
    v_mfma_f32_32x32x16_bf16 v[104:119], v[156:159], v[140:143], v[104:119]
    ds_read_b64_tr_b16 v[172:173], v23 offset:18432
    ds_read_b64_tr_b16 v[174:175], v23 offset:18944
    s_waitcnt lgkmcnt(8)
    v_mfma_f32_32x32x16_bf16 v[72:87], v[160:163], v[136:139], v[72:87]
    v_mfma_f32_32x32x16_bf16 v[120:135], v[160:163], v[140:143], v[120:135]
    s_waitcnt lgkmcnt(0)
    s_barrier
    v_mfma_f32_32x32x16_bf16 v[40:55], v[164:167], v[144:147], v[40:55]
    ds_read_b128 v[136:139], v17 offset:16384
    ds_read_b64_tr_b16 v[152:153], v21 offset:32768
    v_mfma_f32_32x32x16_bf16 v[56:71], v[168:171], v[144:147], v[56:71]
    ds_read_b64_tr_b16 v[154:155], v21 offset:33280
    ds_read_b64_tr_b16 v[156:157], v22 offset:32768
    v_mfma_f32_32x32x16_bf16 v[88:103], v[164:167], v[148:151], v[88:103]
    ds_read_b64_tr_b16 v[158:159], v22 offset:33280
    ds_read_b128 v[140:143], v17 offset:20480
    v_mfma_f32_32x32x16_bf16 v[104:119], v[168:171], v[148:151], v[104:119]
    ds_read_b64_tr_b16 v[160:161], v23 offset:32768
    ds_read_b64_tr_b16 v[162:163], v23 offset:33280
    v_mfma_f32_32x32x16_bf16 v[72:87], v[172:175], v[144:147], v[72:87]
    v_mfma_f32_32x32x16_bf16 v[120:135], v[172:175], v[148:151], v[120:135]
    s_waitcnt lgkmcnt(5)
    v_mfma_f32_32x32x16_bf16 v[40:55], v[152:155], v[136:139], v[40:55]
    ds_read_b128 v[144:147], v18 offset:16384
    ds_read_b64_tr_b16 v[164:165], v21 offset:34816
    s_waitcnt lgkmcnt(5)
    v_mfma_f32_32x32x16_bf16 v[56:71], v[156:159], v[136:139], v[56:71]
    ds_read_b64_tr_b16 v[166:167], v21 offset:35328
    ds_read_b64_tr_b16 v[168:169], v22 offset:34816
    s_waitcnt lgkmcnt(6)
    v_mfma_f32_32x32x16_bf16 v[88:103], v[152:155], v[140:143], v[88:103]
    ds_read_b64_tr_b16 v[170:171], v22 offset:35328
    ds_read_b128 v[148:151], v18 offset:20480
    v_mfma_f32_32x32x16_bf16 v[104:119], v[156:159], v[140:143], v[104:119]
    ds_read_b64_tr_b16 v[172:173], v23 offset:34816
    ds_read_b64_tr_b16 v[174:175], v23 offset:35328
    s_waitcnt lgkmcnt(8)
    v_mfma_f32_32x32x16_bf16 v[72:87], v[160:163], v[136:139], v[72:87]
    v_mfma_f32_32x32x16_bf16 v[120:135], v[160:163], v[140:143], v[120:135]
    s_waitcnt lgkmcnt(0)
    s_barrier
    v_mfma_f32_32x32x16_bf16 v[40:55], v[164:167], v[144:147], v[40:55]
    ds_read_b128 v[136:139], v19 offset:16384
    ds_read_b64_tr_b16 v[152:153], v21 offset:49152
    v_mfma_f32_32x32x16_bf16 v[56:71], v[168:171], v[144:147], v[56:71]
    ds_read_b64_tr_b16 v[154:155], v21 offset:49664
    ds_read_b64_tr_b16 v[156:157], v22 offset:49152
    v_mfma_f32_32x32x16_bf16 v[88:103], v[164:167], v[148:151], v[88:103]
    ds_read_b64_tr_b16 v[158:159], v22 offset:49664
    ds_read_b128 v[140:143], v19 offset:20480
    v_mfma_f32_32x32x16_bf16 v[104:119], v[168:171], v[148:151], v[104:119]
    ds_read_b64_tr_b16 v[160:161], v23 offset:49152
    ds_read_b64_tr_b16 v[162:163], v23 offset:49664
    v_mfma_f32_32x32x16_bf16 v[72:87], v[172:175], v[144:147], v[72:87]
    v_mfma_f32_32x32x16_bf16 v[120:135], v[172:175], v[148:151], v[120:135]
    s_waitcnt lgkmcnt(5)
    v_mfma_f32_32x32x16_bf16 v[40:55], v[152:155], v[136:139], v[40:55]
    ds_read_b128 v[144:147], v20 offset:16384
    ds_read_b64_tr_b16 v[164:165], v21 offset:51200
    s_waitcnt lgkmcnt(5)
    v_mfma_f32_32x32x16_bf16 v[56:71], v[156:159], v[136:139], v[56:71]
    ds_read_b64_tr_b16 v[166:167], v21 offset:51712
    ds_read_b64_tr_b16 v[168:169], v22 offset:51200
    s_waitcnt lgkmcnt(6)
    v_mfma_f32_32x32x16_bf16 v[88:103], v[152:155], v[140:143], v[88:103]
    ds_read_b64_tr_b16 v[170:171], v22 offset:51712
    ds_read_b128 v[148:151], v20 offset:20480
    v_mfma_f32_32x32x16_bf16 v[104:119], v[156:159], v[140:143], v[104:119]
    ds_read_b64_tr_b16 v[172:173], v23 offset:51200
    ds_read_b64_tr_b16 v[174:175], v23 offset:51712
    s_waitcnt lgkmcnt(8)
    v_mfma_f32_32x32x16_bf16 v[72:87], v[160:163], v[136:139], v[72:87]
    v_mfma_f32_32x32x16_bf16 v[120:135], v[160:163], v[140:143], v[120:135]
    s_waitcnt lgkmcnt(0)
    s_barrier
    v_mfma_f32_32x32x16_bf16 v[40:55], v[164:167], v[144:147], v[40:55]
    ds_read_b128 v[136:139], v17 offset:32768
    ds_read_b64_tr_b16 v[152:153], v24 offset:0
    v_mfma_f32_32x32x16_bf16 v[56:71], v[168:171], v[144:147], v[56:71]
    ds_read_b64_tr_b16 v[154:155], v24 offset:512
    ds_read_b64_tr_b16 v[156:157], v25 offset:0
    v_mfma_f32_32x32x16_bf16 v[88:103], v[164:167], v[148:151], v[88:103]
    ds_read_b64_tr_b16 v[158:159], v25 offset:512
    ds_read_b128 v[140:143], v17 offset:36864
    v_mfma_f32_32x32x16_bf16 v[104:119], v[168:171], v[148:151], v[104:119]
    ds_read_b64_tr_b16 v[160:161], v26 offset:0
    ds_read_b64_tr_b16 v[162:163], v26 offset:512
    v_mfma_f32_32x32x16_bf16 v[72:87], v[172:175], v[144:147], v[72:87]
    v_mfma_f32_32x32x16_bf16 v[120:135], v[172:175], v[148:151], v[120:135]
    s_waitcnt lgkmcnt(5)
    v_mfma_f32_32x32x16_bf16 v[40:55], v[152:155], v[136:139], v[40:55]
    ds_read_b128 v[144:147], v18 offset:32768
    ds_read_b64_tr_b16 v[164:165], v24 offset:2048
    s_waitcnt lgkmcnt(5)
    v_mfma_f32_32x32x16_bf16 v[56:71], v[156:159], v[136:139], v[56:71]
    ds_read_b64_tr_b16 v[166:167], v24 offset:2560
    ds_read_b64_tr_b16 v[168:169], v25 offset:2048
    s_waitcnt lgkmcnt(6)
    v_mfma_f32_32x32x16_bf16 v[88:103], v[152:155], v[140:143], v[88:103]
    ds_read_b64_tr_b16 v[170:171], v25 offset:2560
    ds_read_b128 v[148:151], v18 offset:36864
    v_mfma_f32_32x32x16_bf16 v[104:119], v[156:159], v[140:143], v[104:119]
    ds_read_b64_tr_b16 v[172:173], v26 offset:2048
    ds_read_b64_tr_b16 v[174:175], v26 offset:2560
    s_waitcnt lgkmcnt(8)
    v_mfma_f32_32x32x16_bf16 v[72:87], v[160:163], v[136:139], v[72:87]
    v_mfma_f32_32x32x16_bf16 v[120:135], v[160:163], v[140:143], v[120:135]
    s_waitcnt lgkmcnt(0)
    s_barrier
    v_mfma_f32_32x32x16_bf16 v[40:55], v[164:167], v[144:147], v[40:55]
    ds_read_b128 v[136:139], v19 offset:32768
    ds_read_b64_tr_b16 v[152:153], v24 offset:16384
    v_mfma_f32_32x32x16_bf16 v[56:71], v[168:171], v[144:147], v[56:71]
    ds_read_b64_tr_b16 v[154:155], v24 offset:16896
    ds_read_b64_tr_b16 v[156:157], v25 offset:16384
    v_mfma_f32_32x32x16_bf16 v[88:103], v[164:167], v[148:151], v[88:103]
    ds_read_b64_tr_b16 v[158:159], v25 offset:16896
    ds_read_b128 v[140:143], v19 offset:36864
    v_mfma_f32_32x32x16_bf16 v[104:119], v[168:171], v[148:151], v[104:119]
    ds_read_b64_tr_b16 v[160:161], v26 offset:16384
    ds_read_b64_tr_b16 v[162:163], v26 offset:16896
    v_mfma_f32_32x32x16_bf16 v[72:87], v[172:175], v[144:147], v[72:87]
    v_mfma_f32_32x32x16_bf16 v[120:135], v[172:175], v[148:151], v[120:135]
    s_waitcnt lgkmcnt(5)
    v_mfma_f32_32x32x16_bf16 v[40:55], v[152:155], v[136:139], v[40:55]
    ds_read_b128 v[144:147], v20 offset:32768
    ds_read_b64_tr_b16 v[164:165], v24 offset:18432
    s_waitcnt lgkmcnt(5)
    v_mfma_f32_32x32x16_bf16 v[56:71], v[156:159], v[136:139], v[56:71]
    ds_read_b64_tr_b16 v[166:167], v24 offset:18944
    ds_read_b64_tr_b16 v[168:169], v25 offset:18432
    s_waitcnt lgkmcnt(6)
    v_mfma_f32_32x32x16_bf16 v[88:103], v[152:155], v[140:143], v[88:103]
    ds_read_b64_tr_b16 v[170:171], v25 offset:18944
    ds_read_b128 v[148:151], v20 offset:36864
    v_mfma_f32_32x32x16_bf16 v[104:119], v[156:159], v[140:143], v[104:119]
    ds_read_b64_tr_b16 v[172:173], v26 offset:18432
    ds_read_b64_tr_b16 v[174:175], v26 offset:18944
    s_waitcnt lgkmcnt(8)
    v_mfma_f32_32x32x16_bf16 v[72:87], v[160:163], v[136:139], v[72:87]
    v_mfma_f32_32x32x16_bf16 v[120:135], v[160:163], v[140:143], v[120:135]
    s_waitcnt lgkmcnt(0)
    s_barrier
    v_mfma_f32_32x32x16_bf16 v[40:55], v[164:167], v[144:147], v[40:55]
    ds_read_b128 v[136:139], v17 offset:49152
    ds_read_b64_tr_b16 v[152:153], v21 offset:0
    v_mfma_f32_32x32x16_bf16 v[56:71], v[168:171], v[144:147], v[56:71]
    ds_read_b64_tr_b16 v[154:155], v21 offset:512
    ds_read_b64_tr_b16 v[156:157], v22 offset:0
    v_mfma_f32_32x32x16_bf16 v[88:103], v[164:167], v[148:151], v[88:103]
    ds_read_b64_tr_b16 v[158:159], v22 offset:512
    ds_read_b128 v[140:143], v17 offset:53248
    v_mfma_f32_32x32x16_bf16 v[104:119], v[168:171], v[148:151], v[104:119]
    ds_read_b64_tr_b16 v[160:161], v23 offset:0
    ds_read_b64_tr_b16 v[162:163], v23 offset:512
    v_mfma_f32_32x32x16_bf16 v[72:87], v[172:175], v[144:147], v[72:87]
    v_mfma_f32_32x32x16_bf16 v[120:135], v[172:175], v[148:151], v[120:135]
    s_waitcnt lgkmcnt(5)
    v_mfma_f32_32x32x16_bf16 v[40:55], v[152:155], v[136:139], v[40:55]
    ds_read_b128 v[144:147], v18 offset:49152
    ds_read_b64_tr_b16 v[164:165], v21 offset:2048
    s_waitcnt lgkmcnt(5)
    v_mfma_f32_32x32x16_bf16 v[56:71], v[156:159], v[136:139], v[56:71]
    ds_read_b64_tr_b16 v[166:167], v21 offset:2560
    ds_read_b64_tr_b16 v[168:169], v22 offset:2048
    s_waitcnt lgkmcnt(6)
    v_mfma_f32_32x32x16_bf16 v[88:103], v[152:155], v[140:143], v[88:103]
    ds_read_b64_tr_b16 v[170:171], v22 offset:2560
    ds_read_b128 v[148:151], v18 offset:53248
    v_mfma_f32_32x32x16_bf16 v[104:119], v[156:159], v[140:143], v[104:119]
    ds_read_b64_tr_b16 v[172:173], v23 offset:2048
    ds_read_b64_tr_b16 v[174:175], v23 offset:2560
    s_waitcnt lgkmcnt(8)
    v_mfma_f32_32x32x16_bf16 v[72:87], v[160:163], v[136:139], v[72:87]
    v_mfma_f32_32x32x16_bf16 v[120:135], v[160:163], v[140:143], v[120:135]
    s_waitcnt lgkmcnt(0)
    s_barrier
    v_mfma_f32_32x32x16_bf16 v[40:55], v[164:167], v[144:147], v[40:55]
    ds_read_b128 v[136:139], v19 offset:49152
    ds_read_b64_tr_b16 v[152:153], v21 offset:16384
    v_mfma_f32_32x32x16_bf16 v[56:71], v[168:171], v[144:147], v[56:71]
    ds_read_b64_tr_b16 v[154:155], v21 offset:16896
    ds_read_b64_tr_b16 v[156:157], v22 offset:16384
    v_mfma_f32_32x32x16_bf16 v[88:103], v[164:167], v[148:151], v[88:103]
    ds_read_b64_tr_b16 v[158:159], v22 offset:16896
    ds_read_b128 v[140:143], v19 offset:53248
    v_mfma_f32_32x32x16_bf16 v[104:119], v[168:171], v[148:151], v[104:119]
    ds_read_b64_tr_b16 v[160:161], v23 offset:16384
    ds_read_b64_tr_b16 v[162:163], v23 offset:16896
    v_mfma_f32_32x32x16_bf16 v[72:87], v[172:175], v[144:147], v[72:87]
    v_mfma_f32_32x32x16_bf16 v[120:135], v[172:175], v[148:151], v[120:135]
    s_waitcnt lgkmcnt(5)
    v_mfma_f32_32x32x16_bf16 v[40:55], v[152:155], v[136:139], v[40:55]
    ds_read_b128 v[144:147], v20 offset:49152
    ds_read_b64_tr_b16 v[164:165], v21 offset:18432
    s_waitcnt lgkmcnt(5)
    v_mfma_f32_32x32x16_bf16 v[56:71], v[156:159], v[136:139], v[56:71]
    ds_read_b64_tr_b16 v[166:167], v21 offset:18944
    ds_read_b64_tr_b16 v[168:169], v22 offset:18432
    s_waitcnt lgkmcnt(6)
    v_mfma_f32_32x32x16_bf16 v[88:103], v[152:155], v[140:143], v[88:103]
    ds_read_b64_tr_b16 v[170:171], v22 offset:18944
    ds_read_b128 v[148:151], v20 offset:53248
    v_mfma_f32_32x32x16_bf16 v[104:119], v[156:159], v[140:143], v[104:119]
    ds_read_b64_tr_b16 v[172:173], v23 offset:18432
    ds_read_b64_tr_b16 v[174:175], v23 offset:18944
    s_waitcnt lgkmcnt(8)
    v_mfma_f32_32x32x16_bf16 v[72:87], v[160:163], v[136:139], v[72:87]
    v_mfma_f32_32x32x16_bf16 v[120:135], v[160:163], v[140:143], v[120:135]
    s_waitcnt lgkmcnt(0)
    s_barrier
    v_mfma_f32_32x32x16_bf16 v[40:55], v[164:167], v[144:147], v[40:55]
    ds_read_b128 v[136:139], v17 offset:0
    ds_read_b64_tr_b16 v[152:153], v21 offset:32768
    v_mfma_f32_32x32x16_bf16 v[56:71], v[168:171], v[144:147], v[56:71]
    ds_read_b64_tr_b16 v[154:155], v21 offset:33280
    ds_read_b64_tr_b16 v[156:157], v22 offset:32768
    v_mfma_f32_32x32x16_bf16 v[88:103], v[164:167], v[148:151], v[88:103]
    ds_read_b64_tr_b16 v[158:159], v22 offset:33280
    ds_read_b128 v[140:143], v17 offset:4096
    v_mfma_f32_32x32x16_bf16 v[104:119], v[168:171], v[148:151], v[104:119]
    ds_read_b64_tr_b16 v[160:161], v23 offset:32768
    ds_read_b64_tr_b16 v[162:163], v23 offset:33280
    v_mfma_f32_32x32x16_bf16 v[72:87], v[172:175], v[144:147], v[72:87]
    v_mfma_f32_32x32x16_bf16 v[120:135], v[172:175], v[148:151], v[120:135]
    s_waitcnt lgkmcnt(5)
    v_mfma_f32_32x32x16_bf16 v[40:55], v[152:155], v[136:139], v[40:55]
    ds_read_b128 v[144:147], v18 offset:0
    ds_read_b64_tr_b16 v[164:165], v21 offset:34816
    s_waitcnt lgkmcnt(5)
    v_mfma_f32_32x32x16_bf16 v[56:71], v[156:159], v[136:139], v[56:71]
    ds_read_b64_tr_b16 v[166:167], v21 offset:35328
    ds_read_b64_tr_b16 v[168:169], v22 offset:34816
    s_waitcnt lgkmcnt(6)
    v_mfma_f32_32x32x16_bf16 v[88:103], v[152:155], v[140:143], v[88:103]
    ds_read_b64_tr_b16 v[170:171], v22 offset:35328
    ds_read_b128 v[148:151], v18 offset:4096
    v_mfma_f32_32x32x16_bf16 v[104:119], v[156:159], v[140:143], v[104:119]
    ds_read_b64_tr_b16 v[172:173], v23 offset:34816
    ds_read_b64_tr_b16 v[174:175], v23 offset:35328
    s_waitcnt lgkmcnt(8)
    v_mfma_f32_32x32x16_bf16 v[72:87], v[160:163], v[136:139], v[72:87]
    v_mfma_f32_32x32x16_bf16 v[120:135], v[160:163], v[140:143], v[120:135]
    v_mov_b32 v36, 0
    buffer_load_dword v36, v36, s[20:23], 0 offen sc1
    s_waitcnt lgkmcnt(0)
    s_barrier
    v_mfma_f32_32x32x16_bf16 v[40:55], v[164:167], v[144:147], v[40:55]
    ds_read_b128 v[136:139], v19 offset:0
    ds_read_b64_tr_b16 v[152:153], v21 offset:49152
    v_mfma_f32_32x32x16_bf16 v[56:71], v[168:171], v[144:147], v[56:71]
    ds_read_b64_tr_b16 v[154:155], v21 offset:49664
    ds_read_b64_tr_b16 v[156:157], v22 offset:49152
    v_mfma_f32_32x32x16_bf16 v[88:103], v[164:167], v[148:151], v[88:103]
    ds_read_b64_tr_b16 v[158:159], v22 offset:49664
    ds_read_b128 v[140:143], v19 offset:4096
    v_mfma_f32_32x32x16_bf16 v[104:119], v[168:171], v[148:151], v[104:119]
    ds_read_b64_tr_b16 v[160:161], v23 offset:49152
    ds_read_b64_tr_b16 v[162:163], v23 offset:49664
    v_mfma_f32_32x32x16_bf16 v[72:87], v[172:175], v[144:147], v[72:87]
    v_mfma_f32_32x32x16_bf16 v[120:135], v[172:175], v[148:151], v[120:135]
    s_waitcnt lgkmcnt(5)
    v_mfma_f32_32x32x16_bf16 v[40:55], v[152:155], v[136:139], v[40:55]
    ds_read_b128 v[144:147], v20 offset:0
    ds_read_b64_tr_b16 v[164:165], v21 offset:51200
    s_waitcnt lgkmcnt(5)
    v_mfma_f32_32x32x16_bf16 v[56:71], v[156:159], v[136:139], v[56:71]
    ds_read_b64_tr_b16 v[166:167], v21 offset:51712
    ds_read_b64_tr_b16 v[168:169], v22 offset:51200
    s_waitcnt lgkmcnt(6)
    v_mfma_f32_32x32x16_bf16 v[88:103], v[152:155], v[140:143], v[88:103]
    ds_read_b64_tr_b16 v[170:171], v22 offset:51712
    ds_read_b128 v[148:151], v20 offset:4096
    v_mfma_f32_32x32x16_bf16 v[104:119], v[156:159], v[140:143], v[104:119]
    ds_read_b64_tr_b16 v[172:173], v23 offset:51200
    ds_read_b64_tr_b16 v[174:175], v23 offset:51712
    s_waitcnt lgkmcnt(8)
    v_mfma_f32_32x32x16_bf16 v[72:87], v[160:163], v[136:139], v[72:87]
    v_mfma_f32_32x32x16_bf16 v[120:135], v[160:163], v[140:143], v[120:135]
    s_waitcnt lgkmcnt(0)
    s_barrier
    v_mfma_f32_32x32x16_bf16 v[40:55], v[164:167], v[144:147], v[40:55]
    ds_read_b128 v[136:139], v17 offset:16384
    ds_read_b64_tr_b16 v[152:153], v24 offset:0
    v_mfma_f32_32x32x16_bf16 v[56:71], v[168:171], v[144:147], v[56:71]
    ds_read_b64_tr_b16 v[154:155], v24 offset:512
    ds_read_b64_tr_b16 v[156:157], v25 offset:0
    v_mfma_f32_32x32x16_bf16 v[88:103], v[164:167], v[148:151], v[88:103]
    ds_read_b64_tr_b16 v[158:159], v25 offset:512
    ds_read_b128 v[140:143], v17 offset:20480
    v_mfma_f32_32x32x16_bf16 v[104:119], v[168:171], v[148:151], v[104:119]
    ds_read_b64_tr_b16 v[160:161], v26 offset:0
    ds_read_b64_tr_b16 v[162:163], v26 offset:512
    v_mfma_f32_32x32x16_bf16 v[72:87], v[172:175], v[144:147], v[72:87]
    v_mfma_f32_32x32x16_bf16 v[120:135], v[172:175], v[148:151], v[120:135]
    s_waitcnt lgkmcnt(5)
    v_mfma_f32_32x32x16_bf16 v[40:55], v[152:155], v[136:139], v[40:55]
    ds_read_b128 v[144:147], v18 offset:16384
    ds_read_b64_tr_b16 v[164:165], v24 offset:2048
    s_waitcnt lgkmcnt(5)
    v_mfma_f32_32x32x16_bf16 v[56:71], v[156:159], v[136:139], v[56:71]
    ds_read_b64_tr_b16 v[166:167], v24 offset:2560
    ds_read_b64_tr_b16 v[168:169], v25 offset:2048
    s_waitcnt lgkmcnt(6)
    v_mfma_f32_32x32x16_bf16 v[88:103], v[152:155], v[140:143], v[88:103]
    ds_read_b64_tr_b16 v[170:171], v25 offset:2560
    ds_read_b128 v[148:151], v18 offset:20480
    v_mfma_f32_32x32x16_bf16 v[104:119], v[156:159], v[140:143], v[104:119]
    ds_read_b64_tr_b16 v[172:173], v26 offset:2048
    ds_read_b64_tr_b16 v[174:175], v26 offset:2560
    s_waitcnt lgkmcnt(8)
    v_mfma_f32_32x32x16_bf16 v[72:87], v[160:163], v[136:139], v[72:87]
    v_mfma_f32_32x32x16_bf16 v[120:135], v[160:163], v[140:143], v[120:135]
    s_waitcnt lgkmcnt(0)
    s_barrier
    v_mfma_f32_32x32x16_bf16 v[40:55], v[164:167], v[144:147], v[40:55]
    ds_read_b128 v[136:139], v19 offset:16384
    ds_read_b64_tr_b16 v[152:153], v24 offset:16384
    v_mfma_f32_32x32x16_bf16 v[56:71], v[168:171], v[144:147], v[56:71]
    ds_read_b64_tr_b16 v[154:155], v24 offset:16896
    ds_read_b64_tr_b16 v[156:157], v25 offset:16384
    v_mfma_f32_32x32x16_bf16 v[88:103], v[164:167], v[148:151], v[88:103]
    ds_read_b64_tr_b16 v[158:159], v25 offset:16896
    ds_read_b128 v[140:143], v19 offset:20480
    v_mfma_f32_32x32x16_bf16 v[104:119], v[168:171], v[148:151], v[104:119]
    ds_read_b64_tr_b16 v[160:161], v26 offset:16384
    ds_read_b64_tr_b16 v[162:163], v26 offset:16896
    v_mfma_f32_32x32x16_bf16 v[72:87], v[172:175], v[144:147], v[72:87]
    v_mfma_f32_32x32x16_bf16 v[120:135], v[172:175], v[148:151], v[120:135]
    s_waitcnt lgkmcnt(5)
    v_mfma_f32_32x32x16_bf16 v[40:55], v[152:155], v[136:139], v[40:55]
    ds_read_b128 v[144:147], v20 offset:16384
    ds_read_b64_tr_b16 v[164:165], v24 offset:18432
    s_waitcnt lgkmcnt(5)
    v_mfma_f32_32x32x16_bf16 v[56:71], v[156:159], v[136:139], v[56:71]
    ds_read_b64_tr_b16 v[166:167], v24 offset:18944
    ds_read_b64_tr_b16 v[168:169], v25 offset:18432
    s_waitcnt lgkmcnt(6)
    v_mfma_f32_32x32x16_bf16 v[88:103], v[152:155], v[140:143], v[88:103]
    ds_read_b64_tr_b16 v[170:171], v25 offset:18944
    ds_read_b128 v[148:151], v20 offset:20480
    v_mfma_f32_32x32x16_bf16 v[104:119], v[156:159], v[140:143], v[104:119]
    ds_read_b64_tr_b16 v[172:173], v26 offset:18432
    ds_read_b64_tr_b16 v[174:175], v26 offset:18944
    s_waitcnt lgkmcnt(8)
    v_mfma_f32_32x32x16_bf16 v[72:87], v[160:163], v[136:139], v[72:87]
    v_mfma_f32_32x32x16_bf16 v[120:135], v[160:163], v[140:143], v[120:135]
    s_waitcnt lgkmcnt(0)
    s_barrier
    v_mfma_f32_32x32x16_bf16 v[40:55], v[164:167], v[144:147], v[40:55]
    ds_read_b128 v[192:195], v17 offset:32768
    ds_read_b128 v[196:199], v18 offset:32768
    v_mfma_f32_32x32x16_bf16 v[56:71], v[168:171], v[144:147], v[56:71]
    ds_read_b128 v[200:203], v19 offset:32768
    ds_read_b128 v[204:207], v20 offset:32768
    v_mfma_f32_32x32x16_bf16 v[88:103], v[164:167], v[148:151], v[88:103]
    ds_read_b64_tr_b16 v[208:209], v21 offset:0
    ds_read_b64_tr_b16 v[210:211], v21 offset:512
    v_mfma_f32_32x32x16_bf16 v[104:119], v[168:171], v[148:151], v[104:119]
    ds_read_b64_tr_b16 v[212:213], v21 offset:2048
    ds_read_b64_tr_b16 v[214:215], v21 offset:2560
    v_mfma_f32_32x32x16_bf16 v[72:87], v[172:175], v[144:147], v[72:87]
    ds_read_b64_tr_b16 v[216:217], v21 offset:16384
    ds_read_b64_tr_b16 v[218:219], v21 offset:16896
    v_mfma_f32_32x32x16_bf16 v[120:135], v[172:175], v[148:151], v[120:135]
    ds_read_b64_tr_b16 v[220:221], v21 offset:18432
    ds_read_b64_tr_b16 v[222:223], v21 offset:18944
    s_waitcnt lgkmcnt(0)
    ds_read_b128 v[136:139], v17 offset:36864
    ds_read_b128 v[140:143], v18 offset:36864
    v_mfma_f32_32x32x16_bf16 v[40:55], v[208:211], v[192:195], v[40:55]
    ds_read_b128 v[144:147], v19 offset:36864
    ds_read_b128 v[148:151], v20 offset:36864
    v_mfma_f32_32x32x16_bf16 v[40:55], v[212:215], v[196:199], v[40:55]
    v_mfma_f32_32x32x16_bf16 v[40:55], v[216:219], v[200:203], v[40:55]
    v_mfma_f32_32x32x16_bf16 v[40:55], v[220:223], v[204:207], v[40:55]
    s_waitcnt lgkmcnt(0)
    ds_read_b64_tr_b16 v[152:153], v22 offset:0
    ds_read_b64_tr_b16 v[154:155], v22 offset:512
    v_mfma_f32_32x32x16_bf16 v[88:103], v[208:211], v[136:139], v[88:103]
    ds_read_b64_tr_b16 v[156:157], v22 offset:2048
    ds_read_b64_tr_b16 v[158:159], v22 offset:2560
    v_mfma_f32_32x32x16_bf16 v[88:103], v[212:215], v[140:143], v[88:103]
    s_nop 4
    v_pk_mul_f32 v[40:41], v[40:41], s[4:5]
    v_pk_mul_f32 v[42:43], v[42:43], s[4:5]
    v_pk_mul_f32 v[44:45], v[44:45], s[4:5]
    v_pk_mul_f32 v[46:47], v[46:47], s[4:5]
    v_pk_mul_f32 v[48:49], v[48:49], s[4:5]
    v_pk_mul_f32 v[50:51], v[50:51], s[4:5]
    v_pk_mul_f32 v[52:53], v[52:53], s[4:5]
    ds_read_b64_tr_b16 v[160:161], v22 offset:16384
    ds_read_b64_tr_b16 v[162:163], v22 offset:16896
    v_mfma_f32_32x32x16_bf16 v[88:103], v[216:219], v[144:147], v[88:103]
    v_pk_mul_f32 v[54:55], v[54:55], s[4:5]
    v_cvt_pk_bf16_f32 v176, v40, v41
    v_cvt_pk_bf16_f32 v177, v42, v43
    v_cvt_pk_bf16_f32 v178, v44, v45
    v_cvt_pk_bf16_f32 v179, v46, v47
    v_cvt_pk_bf16_f32 v180, v48, v49
    v_cvt_pk_bf16_f32 v181, v50, v51
    ds_read_b64_tr_b16 v[164:165], v22 offset:18432
    ds_read_b64_tr_b16 v[166:167], v22 offset:18944
    v_mfma_f32_32x32x16_bf16 v[88:103], v[220:223], v[148:151], v[88:103]
    v_cvt_pk_bf16_f32 v182, v52, v53
    v_cvt_pk_bf16_f32 v183, v54, v55
    s_mov_b64 exec, s[34:35]
    v_mov_b32 v182, 1065369472
    v_mov_b32 v183, 0x00003f80
    s_mov_b64 exec, -1
    buffer_store_dwordx4 v[176:179], v27, s[8:11], s66 offen offset:0 sc1
    buffer_store_dwordx4 v[180:183], v27, s[8:11], s66 offen offset:1024 sc1
    s_waitcnt lgkmcnt(0)
    ds_read_b64_tr_b16 v[168:169], v23 offset:0
    ds_read_b64_tr_b16 v[170:171], v23 offset:512
    v_mfma_f32_32x32x16_bf16 v[56:71], v[152:155], v[192:195], v[56:71]
    ds_read_b64_tr_b16 v[172:173], v23 offset:2048
    ds_read_b64_tr_b16 v[174:175], v23 offset:2560
    v_mfma_f32_32x32x16_bf16 v[56:71], v[156:159], v[196:199], v[56:71]
    v_pk_mul_f32 v[88:89], v[88:89], s[4:5]
    v_pk_mul_f32 v[90:91], v[90:91], s[4:5]
    v_pk_mul_f32 v[92:93], v[92:93], s[4:5]
    v_pk_mul_f32 v[94:95], v[94:95], s[4:5]
    v_pk_mul_f32 v[96:97], v[96:97], s[4:5]
    v_pk_mul_f32 v[98:99], v[98:99], s[4:5]
    v_pk_mul_f32 v[100:101], v[100:101], s[4:5]
    ds_read_b64_tr_b16 v[224:225], v23 offset:16384
    ds_read_b64_tr_b16 v[226:227], v23 offset:16896
    v_mfma_f32_32x32x16_bf16 v[56:71], v[160:163], v[200:203], v[56:71]
    v_pk_mul_f32 v[102:103], v[102:103], s[4:5]
    v_cvt_pk_bf16_f32 v184, v88, v89
    v_cvt_pk_bf16_f32 v185, v90, v91
    v_cvt_pk_bf16_f32 v186, v92, v93
    v_cvt_pk_bf16_f32 v187, v94, v95
    v_cvt_pk_bf16_f32 v188, v96, v97
    v_cvt_pk_bf16_f32 v189, v98, v99
    ds_read_b64_tr_b16 v[228:229], v23 offset:18432
    ds_read_b64_tr_b16 v[230:231], v23 offset:18944
    v_mfma_f32_32x32x16_bf16 v[56:71], v[164:167], v[204:207], v[56:71]
    v_cvt_pk_bf16_f32 v190, v100, v101
    v_cvt_pk_bf16_f32 v191, v102, v103
    s_mov_b64 exec, s[34:35]
    v_mov_b32 v190, 1065369472
    v_mov_b32 v191, 0x00003f80
    s_mov_b64 exec, -1
    buffer_store_dwordx4 v[184:187], v27, s[8:11], s66 offen offset:2048 sc1
    buffer_store_dwordx4 v[188:191], v27, s[8:11], s66 offen offset:3072 sc1
    s_waitcnt lgkmcnt(0)
    v_mfma_f32_32x32x16_bf16 v[104:119], v[152:155], v[136:139], v[104:119]
    v_mfma_f32_32x32x16_bf16 v[104:119], v[156:159], v[140:143], v[104:119]
    s_nop 0
    v_pk_mul_f32 v[56:57], v[56:57], s[6:7]
    v_pk_mul_f32 v[58:59], v[58:59], s[6:7]
    v_pk_mul_f32 v[60:61], v[60:61], s[6:7]
    v_pk_mul_f32 v[62:63], v[62:63], s[6:7]
    v_pk_mul_f32 v[64:65], v[64:65], s[6:7]
    v_pk_mul_f32 v[66:67], v[66:67], s[6:7]
    v_pk_mul_f32 v[68:69], v[68:69], s[6:7]
    v_mfma_f32_32x32x16_bf16 v[104:119], v[160:163], v[144:147], v[104:119]
    v_pk_mul_f32 v[70:71], v[70:71], s[6:7]
    v_cvt_pk_bf16_f32 v176, v56, v57
    v_cvt_pk_bf16_f32 v177, v58, v59
    v_cvt_pk_bf16_f32 v178, v60, v61
    v_cvt_pk_bf16_f32 v179, v62, v63
    v_cvt_pk_bf16_f32 v180, v64, v65
    v_cvt_pk_bf16_f32 v181, v66, v67
    v_mfma_f32_32x32x16_bf16 v[104:119], v[164:167], v[148:151], v[104:119]
    v_cvt_pk_bf16_f32 v182, v68, v69
    v_cvt_pk_bf16_f32 v183, v70, v71
    s_mov_b64 exec, s[34:35]
    v_mov_b32 v182, 1065369472
    v_mov_b32 v183, 0x00003f80
    s_mov_b64 exec, -1
    buffer_store_dwordx4 v[176:179], v27, s[8:11], s67 offen offset:0 sc1
    buffer_store_dwordx4 v[180:183], v27, s[8:11], s67 offen offset:1024 sc1
    s_waitcnt lgkmcnt(0)
    v_mfma_f32_32x32x16_bf16 v[72:87], v[168:171], v[192:195], v[72:87]
    v_mfma_f32_32x32x16_bf16 v[72:87], v[172:175], v[196:199], v[72:87]
    s_nop 0
    v_pk_mul_f32 v[104:105], v[104:105], s[6:7]
    v_pk_mul_f32 v[106:107], v[106:107], s[6:7]
    v_pk_mul_f32 v[108:109], v[108:109], s[6:7]
    v_pk_mul_f32 v[110:111], v[110:111], s[6:7]
    v_pk_mul_f32 v[112:113], v[112:113], s[6:7]
    v_pk_mul_f32 v[114:115], v[114:115], s[6:7]
    v_pk_mul_f32 v[116:117], v[116:117], s[6:7]
    v_mfma_f32_32x32x16_bf16 v[72:87], v[224:227], v[200:203], v[72:87]
    v_pk_mul_f32 v[118:119], v[118:119], s[6:7]
    v_cvt_pk_bf16_f32 v184, v104, v105
    v_cvt_pk_bf16_f32 v185, v106, v107
    v_cvt_pk_bf16_f32 v186, v108, v109
    v_cvt_pk_bf16_f32 v187, v110, v111
    v_cvt_pk_bf16_f32 v188, v112, v113
    v_cvt_pk_bf16_f32 v189, v114, v115
    v_mfma_f32_32x32x16_bf16 v[72:87], v[228:231], v[204:207], v[72:87]
    v_cvt_pk_bf16_f32 v190, v116, v117
    v_cvt_pk_bf16_f32 v191, v118, v119
    s_mov_b64 exec, s[34:35]
    v_mov_b32 v190, 1065369472
    v_mov_b32 v191, 0x00003f80
    s_mov_b64 exec, -1
    buffer_store_dwordx4 v[184:187], v27, s[8:11], s67 offen offset:2048 sc1
    buffer_store_dwordx4 v[188:191], v27, s[8:11], s67 offen offset:3072 sc1
    s_waitcnt lgkmcnt(0)
    v_mfma_f32_32x32x16_bf16 v[120:135], v[168:171], v[136:139], v[120:135]
    v_mfma_f32_32x32x16_bf16 v[120:135], v[172:175], v[140:143], v[120:135]
    s_nop 0
    v_pk_mul_f32 v[72:73], v[72:73], s[64:65]
    v_pk_mul_f32 v[74:75], v[74:75], s[64:65]
    v_pk_mul_f32 v[76:77], v[76:77], s[64:65]
    v_pk_mul_f32 v[78:79], v[78:79], s[64:65]
    v_pk_mul_f32 v[80:81], v[80:81], s[64:65]
    v_pk_mul_f32 v[82:83], v[82:83], s[64:65]
    v_pk_mul_f32 v[84:85], v[84:85], s[64:65]
    v_mfma_f32_32x32x16_bf16 v[120:135], v[224:227], v[144:147], v[120:135]
    v_pk_mul_f32 v[86:87], v[86:87], s[64:65]
    v_cvt_pk_bf16_f32 v176, v72, v73
    v_cvt_pk_bf16_f32 v177, v74, v75
    v_cvt_pk_bf16_f32 v178, v76, v77
    v_cvt_pk_bf16_f32 v179, v78, v79
    v_cvt_pk_bf16_f32 v180, v80, v81
    v_cvt_pk_bf16_f32 v181, v82, v83
    v_mfma_f32_32x32x16_bf16 v[120:135], v[228:231], v[148:151], v[120:135]
    v_cvt_pk_bf16_f32 v182, v84, v85
    v_cvt_pk_bf16_f32 v183, v86, v87
    s_mov_b64 exec, s[34:35]
    v_mov_b32 v182, 1065369472
    v_mov_b32 v183, 0x00003f80
    s_mov_b64 exec, -1
    buffer_store_dwordx4 v[176:179], v27, s[8:11], s33 offen offset:0 sc1
    buffer_store_dwordx4 v[180:183], v27, s[8:11], s33 offen offset:1024 sc1
    s_nop 3
    v_pk_mul_f32 v[120:121], v[120:121], s[64:65]
    v_pk_mul_f32 v[122:123], v[122:123], s[64:65]
    v_pk_mul_f32 v[124:125], v[124:125], s[64:65]
    v_pk_mul_f32 v[126:127], v[126:127], s[64:65]
    v_pk_mul_f32 v[128:129], v[128:129], s[64:65]
    v_pk_mul_f32 v[130:131], v[130:131], s[64:65]
    v_pk_mul_f32 v[132:133], v[132:133], s[64:65]
    v_pk_mul_f32 v[134:135], v[134:135], s[64:65]
    v_cvt_pk_bf16_f32 v184, v120, v121
    v_cvt_pk_bf16_f32 v185, v122, v123
    v_cvt_pk_bf16_f32 v186, v124, v125
    v_cvt_pk_bf16_f32 v187, v126, v127
    v_cvt_pk_bf16_f32 v188, v128, v129
    v_cvt_pk_bf16_f32 v189, v130, v131
    v_cvt_pk_bf16_f32 v190, v132, v133
    v_cvt_pk_bf16_f32 v191, v134, v135
    s_mov_b64 exec, s[34:35]
    v_mov_b32 v190, 1065369472
    v_mov_b32 v191, 0x00003f80
    s_mov_b64 exec, -1
    buffer_store_dwordx4 v[184:187], v27, s[8:11], s33 offen offset:2048 sc1
    buffer_store_dwordx4 v[188:191], v27, s[8:11], s33 offen offset:3072 sc1
    s_waitcnt vmcnt(0)
    s_branch concat_heads__linear_kernel_hedgehog__mha_block__prompt_kernel_p1_end
concat_heads__linear_kernel_hedgehog__mha_block__prompt_kernel_TTN:
    s_add_u32 s66, s63, 0
    s_mul_i32 s30, s62, 3
    s_add_u32 s30, s30, 0
    s_cmp_lt_u32 s30, 16
    s_cselect_b32 s30, s27, 0
    s_cmp_eq_u32 s30, 1
    s_cselect_b32 s4, 0x3e8b97f6, 1.0
    s_mov_b32 s5, s4
    s_add_u32 s67, s63, 131072
    s_mul_i32 s30, s62, 3
    s_add_u32 s30, s30, 1
    s_cmp_lt_u32 s30, 16
    s_cselect_b32 s30, s27, 0
    s_cmp_eq_u32 s30, 1
    s_cselect_b32 s6, 0x3e8b97f6, 1.0
    s_mov_b32 s7, s6
    s_add_u32 s33, s63, 262144
    s_barrier
    ds_read_b128 v[136:139], v17 offset:0
    ds_read_b64_tr_b16 v[152:153], v21 offset:0
    ds_read_b64_tr_b16 v[154:155], v21 offset:512
    ds_read_b64_tr_b16 v[156:157], v22 offset:0
    ds_read_b64_tr_b16 v[158:159], v22 offset:512
    ds_read_b128 v[140:143], v17 offset:4096
    ds_read_b64_tr_b16 v[160:161], v23 offset:0
    ds_read_b64_tr_b16 v[162:163], v23 offset:512
    s_waitcnt lgkmcnt(5)
    v_mfma_f32_32x32x16_bf16 v[40:55], v[152:155], v[136:139], 0
    ds_read_b128 v[144:147], v18 offset:0
    ds_read_b64_tr_b16 v[164:165], v21 offset:2048
    s_waitcnt lgkmcnt(5)
    v_mfma_f32_32x32x16_bf16 v[56:71], v[156:159], v[136:139], 0
    ds_read_b64_tr_b16 v[166:167], v21 offset:2560
    ds_read_b64_tr_b16 v[168:169], v22 offset:2048
    s_waitcnt lgkmcnt(6)
    v_mfma_f32_32x32x16_bf16 v[88:103], v[152:155], v[140:143], 0
    ds_read_b64_tr_b16 v[170:171], v22 offset:2560
    ds_read_b128 v[148:151], v18 offset:4096
    v_mfma_f32_32x32x16_bf16 v[104:119], v[156:159], v[140:143], 0
    ds_read_b64_tr_b16 v[172:173], v23 offset:2048
    ds_read_b64_tr_b16 v[174:175], v23 offset:2560
    s_waitcnt lgkmcnt(8)
    v_mfma_f32_32x32x16_bf16 v[72:87], v[136:139], v[160:163], 0
    v_mfma_f32_32x32x16_bf16 v[120:135], v[140:143], v[160:163], 0
    s_waitcnt lgkmcnt(0)
    s_barrier
    v_mfma_f32_32x32x16_bf16 v[40:55], v[164:167], v[144:147], v[40:55]
    ds_read_b128 v[136:139], v19 offset:0
    ds_read_b64_tr_b16 v[152:153], v21 offset:16384
    v_mfma_f32_32x32x16_bf16 v[56:71], v[168:171], v[144:147], v[56:71]
    ds_read_b64_tr_b16 v[154:155], v21 offset:16896
    ds_read_b64_tr_b16 v[156:157], v22 offset:16384
    v_mfma_f32_32x32x16_bf16 v[88:103], v[164:167], v[148:151], v[88:103]
    ds_read_b64_tr_b16 v[158:159], v22 offset:16896
    ds_read_b128 v[140:143], v19 offset:4096
    v_mfma_f32_32x32x16_bf16 v[104:119], v[168:171], v[148:151], v[104:119]
    ds_read_b64_tr_b16 v[160:161], v23 offset:16384
    ds_read_b64_tr_b16 v[162:163], v23 offset:16896
    v_mfma_f32_32x32x16_bf16 v[72:87], v[144:147], v[172:175], v[72:87]
    v_mfma_f32_32x32x16_bf16 v[120:135], v[148:151], v[172:175], v[120:135]
    s_waitcnt lgkmcnt(5)
    v_mfma_f32_32x32x16_bf16 v[40:55], v[152:155], v[136:139], v[40:55]
    ds_read_b128 v[144:147], v20 offset:0
    ds_read_b64_tr_b16 v[164:165], v21 offset:18432
    s_waitcnt lgkmcnt(5)
    v_mfma_f32_32x32x16_bf16 v[56:71], v[156:159], v[136:139], v[56:71]
    ds_read_b64_tr_b16 v[166:167], v21 offset:18944
    ds_read_b64_tr_b16 v[168:169], v22 offset:18432
    s_waitcnt lgkmcnt(6)
    v_mfma_f32_32x32x16_bf16 v[88:103], v[152:155], v[140:143], v[88:103]
    ds_read_b64_tr_b16 v[170:171], v22 offset:18944
    ds_read_b128 v[148:151], v20 offset:4096
    v_mfma_f32_32x32x16_bf16 v[104:119], v[156:159], v[140:143], v[104:119]
    ds_read_b64_tr_b16 v[172:173], v23 offset:18432
    ds_read_b64_tr_b16 v[174:175], v23 offset:18944
    s_waitcnt lgkmcnt(8)
    v_mfma_f32_32x32x16_bf16 v[72:87], v[136:139], v[160:163], v[72:87]
    v_mfma_f32_32x32x16_bf16 v[120:135], v[140:143], v[160:163], v[120:135]
    s_waitcnt lgkmcnt(0)
    s_barrier
    v_mfma_f32_32x32x16_bf16 v[40:55], v[164:167], v[144:147], v[40:55]
    ds_read_b128 v[136:139], v17 offset:16384
    ds_read_b64_tr_b16 v[152:153], v21 offset:32768
    v_mfma_f32_32x32x16_bf16 v[56:71], v[168:171], v[144:147], v[56:71]
    ds_read_b64_tr_b16 v[154:155], v21 offset:33280
    ds_read_b64_tr_b16 v[156:157], v22 offset:32768
    v_mfma_f32_32x32x16_bf16 v[88:103], v[164:167], v[148:151], v[88:103]
    ds_read_b64_tr_b16 v[158:159], v22 offset:33280
    ds_read_b128 v[140:143], v17 offset:20480
    v_mfma_f32_32x32x16_bf16 v[104:119], v[168:171], v[148:151], v[104:119]
    ds_read_b64_tr_b16 v[160:161], v23 offset:32768
    ds_read_b64_tr_b16 v[162:163], v23 offset:33280
    v_mfma_f32_32x32x16_bf16 v[72:87], v[144:147], v[172:175], v[72:87]
    v_mfma_f32_32x32x16_bf16 v[120:135], v[148:151], v[172:175], v[120:135]
    s_waitcnt lgkmcnt(5)
    v_mfma_f32_32x32x16_bf16 v[40:55], v[152:155], v[136:139], v[40:55]
    ds_read_b128 v[144:147], v18 offset:16384
    ds_read_b64_tr_b16 v[164:165], v21 offset:34816
    s_waitcnt lgkmcnt(5)
    v_mfma_f32_32x32x16_bf16 v[56:71], v[156:159], v[136:139], v[56:71]
    ds_read_b64_tr_b16 v[166:167], v21 offset:35328
    ds_read_b64_tr_b16 v[168:169], v22 offset:34816
    s_waitcnt lgkmcnt(6)
    v_mfma_f32_32x32x16_bf16 v[88:103], v[152:155], v[140:143], v[88:103]
    ds_read_b64_tr_b16 v[170:171], v22 offset:35328
    ds_read_b128 v[148:151], v18 offset:20480
    v_mfma_f32_32x32x16_bf16 v[104:119], v[156:159], v[140:143], v[104:119]
    ds_read_b64_tr_b16 v[172:173], v23 offset:34816
    ds_read_b64_tr_b16 v[174:175], v23 offset:35328
    s_waitcnt lgkmcnt(8)
    v_mfma_f32_32x32x16_bf16 v[72:87], v[136:139], v[160:163], v[72:87]
    v_mfma_f32_32x32x16_bf16 v[120:135], v[140:143], v[160:163], v[120:135]
    s_waitcnt lgkmcnt(0)
    s_barrier
    v_mfma_f32_32x32x16_bf16 v[40:55], v[164:167], v[144:147], v[40:55]
    ds_read_b128 v[136:139], v19 offset:16384
    ds_read_b64_tr_b16 v[152:153], v21 offset:49152
    v_mfma_f32_32x32x16_bf16 v[56:71], v[168:171], v[144:147], v[56:71]
    ds_read_b64_tr_b16 v[154:155], v21 offset:49664
    ds_read_b64_tr_b16 v[156:157], v22 offset:49152
    v_mfma_f32_32x32x16_bf16 v[88:103], v[164:167], v[148:151], v[88:103]
    ds_read_b64_tr_b16 v[158:159], v22 offset:49664
    ds_read_b128 v[140:143], v19 offset:20480
    v_mfma_f32_32x32x16_bf16 v[104:119], v[168:171], v[148:151], v[104:119]
    ds_read_b64_tr_b16 v[160:161], v23 offset:49152
    ds_read_b64_tr_b16 v[162:163], v23 offset:49664
    v_mfma_f32_32x32x16_bf16 v[72:87], v[144:147], v[172:175], v[72:87]
    v_mfma_f32_32x32x16_bf16 v[120:135], v[148:151], v[172:175], v[120:135]
    s_waitcnt lgkmcnt(5)
    v_mfma_f32_32x32x16_bf16 v[40:55], v[152:155], v[136:139], v[40:55]
    ds_read_b128 v[144:147], v20 offset:16384
    ds_read_b64_tr_b16 v[164:165], v21 offset:51200
    s_waitcnt lgkmcnt(5)
    v_mfma_f32_32x32x16_bf16 v[56:71], v[156:159], v[136:139], v[56:71]
    ds_read_b64_tr_b16 v[166:167], v21 offset:51712
    ds_read_b64_tr_b16 v[168:169], v22 offset:51200
    s_waitcnt lgkmcnt(6)
    v_mfma_f32_32x32x16_bf16 v[88:103], v[152:155], v[140:143], v[88:103]
    ds_read_b64_tr_b16 v[170:171], v22 offset:51712
    ds_read_b128 v[148:151], v20 offset:20480
    v_mfma_f32_32x32x16_bf16 v[104:119], v[156:159], v[140:143], v[104:119]
    ds_read_b64_tr_b16 v[172:173], v23 offset:51200
    ds_read_b64_tr_b16 v[174:175], v23 offset:51712
    s_waitcnt lgkmcnt(8)
    v_mfma_f32_32x32x16_bf16 v[72:87], v[136:139], v[160:163], v[72:87]
    v_mfma_f32_32x32x16_bf16 v[120:135], v[140:143], v[160:163], v[120:135]
    s_waitcnt lgkmcnt(0)
    s_barrier
    v_mfma_f32_32x32x16_bf16 v[40:55], v[164:167], v[144:147], v[40:55]
    ds_read_b128 v[136:139], v17 offset:32768
    ds_read_b64_tr_b16 v[152:153], v24 offset:0
    v_mfma_f32_32x32x16_bf16 v[56:71], v[168:171], v[144:147], v[56:71]
    ds_read_b64_tr_b16 v[154:155], v24 offset:512
    ds_read_b64_tr_b16 v[156:157], v25 offset:0
    v_mfma_f32_32x32x16_bf16 v[88:103], v[164:167], v[148:151], v[88:103]
    ds_read_b64_tr_b16 v[158:159], v25 offset:512
    ds_read_b128 v[140:143], v17 offset:36864
    v_mfma_f32_32x32x16_bf16 v[104:119], v[168:171], v[148:151], v[104:119]
    ds_read_b64_tr_b16 v[160:161], v26 offset:0
    ds_read_b64_tr_b16 v[162:163], v26 offset:512
    v_mfma_f32_32x32x16_bf16 v[72:87], v[144:147], v[172:175], v[72:87]
    v_mfma_f32_32x32x16_bf16 v[120:135], v[148:151], v[172:175], v[120:135]
    s_waitcnt lgkmcnt(5)
    v_mfma_f32_32x32x16_bf16 v[40:55], v[152:155], v[136:139], v[40:55]
    ds_read_b128 v[144:147], v18 offset:32768
    ds_read_b64_tr_b16 v[164:165], v24 offset:2048
    s_waitcnt lgkmcnt(5)
    v_mfma_f32_32x32x16_bf16 v[56:71], v[156:159], v[136:139], v[56:71]
    ds_read_b64_tr_b16 v[166:167], v24 offset:2560
    ds_read_b64_tr_b16 v[168:169], v25 offset:2048
    s_waitcnt lgkmcnt(6)
    v_mfma_f32_32x32x16_bf16 v[88:103], v[152:155], v[140:143], v[88:103]
    ds_read_b64_tr_b16 v[170:171], v25 offset:2560
    ds_read_b128 v[148:151], v18 offset:36864
    v_mfma_f32_32x32x16_bf16 v[104:119], v[156:159], v[140:143], v[104:119]
    ds_read_b64_tr_b16 v[172:173], v26 offset:2048
    ds_read_b64_tr_b16 v[174:175], v26 offset:2560
    s_waitcnt lgkmcnt(8)
    v_mfma_f32_32x32x16_bf16 v[72:87], v[136:139], v[160:163], v[72:87]
    v_mfma_f32_32x32x16_bf16 v[120:135], v[140:143], v[160:163], v[120:135]
    s_waitcnt lgkmcnt(0)
    s_barrier
    v_mfma_f32_32x32x16_bf16 v[40:55], v[164:167], v[144:147], v[40:55]
    ds_read_b128 v[136:139], v19 offset:32768
    ds_read_b64_tr_b16 v[152:153], v24 offset:16384
    v_mfma_f32_32x32x16_bf16 v[56:71], v[168:171], v[144:147], v[56:71]
    ds_read_b64_tr_b16 v[154:155], v24 offset:16896
    ds_read_b64_tr_b16 v[156:157], v25 offset:16384
    v_mfma_f32_32x32x16_bf16 v[88:103], v[164:167], v[148:151], v[88:103]
    ds_read_b64_tr_b16 v[158:159], v25 offset:16896
    ds_read_b128 v[140:143], v19 offset:36864
    v_mfma_f32_32x32x16_bf16 v[104:119], v[168:171], v[148:151], v[104:119]
    ds_read_b64_tr_b16 v[160:161], v26 offset:16384
    ds_read_b64_tr_b16 v[162:163], v26 offset:16896
    v_mfma_f32_32x32x16_bf16 v[72:87], v[144:147], v[172:175], v[72:87]
    v_mfma_f32_32x32x16_bf16 v[120:135], v[148:151], v[172:175], v[120:135]
    s_waitcnt lgkmcnt(5)
    v_mfma_f32_32x32x16_bf16 v[40:55], v[152:155], v[136:139], v[40:55]
    ds_read_b128 v[144:147], v20 offset:32768
    ds_read_b64_tr_b16 v[164:165], v24 offset:18432
    s_waitcnt lgkmcnt(5)
    v_mfma_f32_32x32x16_bf16 v[56:71], v[156:159], v[136:139], v[56:71]
    ds_read_b64_tr_b16 v[166:167], v24 offset:18944
    ds_read_b64_tr_b16 v[168:169], v25 offset:18432
    s_waitcnt lgkmcnt(6)
    v_mfma_f32_32x32x16_bf16 v[88:103], v[152:155], v[140:143], v[88:103]
    ds_read_b64_tr_b16 v[170:171], v25 offset:18944
    ds_read_b128 v[148:151], v20 offset:36864
    v_mfma_f32_32x32x16_bf16 v[104:119], v[156:159], v[140:143], v[104:119]
    ds_read_b64_tr_b16 v[172:173], v26 offset:18432
    ds_read_b64_tr_b16 v[174:175], v26 offset:18944
    s_waitcnt lgkmcnt(8)
    v_mfma_f32_32x32x16_bf16 v[72:87], v[136:139], v[160:163], v[72:87]
    v_mfma_f32_32x32x16_bf16 v[120:135], v[140:143], v[160:163], v[120:135]
    s_waitcnt lgkmcnt(0)
    s_barrier
    v_mfma_f32_32x32x16_bf16 v[40:55], v[164:167], v[144:147], v[40:55]
    ds_read_b128 v[136:139], v17 offset:49152
    ds_read_b64_tr_b16 v[152:153], v21 offset:0
    v_mfma_f32_32x32x16_bf16 v[56:71], v[168:171], v[144:147], v[56:71]
    ds_read_b64_tr_b16 v[154:155], v21 offset:512
    ds_read_b64_tr_b16 v[156:157], v22 offset:0
    v_mfma_f32_32x32x16_bf16 v[88:103], v[164:167], v[148:151], v[88:103]
    ds_read_b64_tr_b16 v[158:159], v22 offset:512
    ds_read_b128 v[140:143], v17 offset:53248
    v_mfma_f32_32x32x16_bf16 v[104:119], v[168:171], v[148:151], v[104:119]
    ds_read_b64_tr_b16 v[160:161], v23 offset:0
    ds_read_b64_tr_b16 v[162:163], v23 offset:512
    v_mfma_f32_32x32x16_bf16 v[72:87], v[144:147], v[172:175], v[72:87]
    v_mfma_f32_32x32x16_bf16 v[120:135], v[148:151], v[172:175], v[120:135]
    s_waitcnt lgkmcnt(5)
    v_mfma_f32_32x32x16_bf16 v[40:55], v[152:155], v[136:139], v[40:55]
    ds_read_b128 v[144:147], v18 offset:49152
    ds_read_b64_tr_b16 v[164:165], v21 offset:2048
    s_waitcnt lgkmcnt(5)
    v_mfma_f32_32x32x16_bf16 v[56:71], v[156:159], v[136:139], v[56:71]
    ds_read_b64_tr_b16 v[166:167], v21 offset:2560
    ds_read_b64_tr_b16 v[168:169], v22 offset:2048
    s_waitcnt lgkmcnt(6)
    v_mfma_f32_32x32x16_bf16 v[88:103], v[152:155], v[140:143], v[88:103]
    ds_read_b64_tr_b16 v[170:171], v22 offset:2560
    ds_read_b128 v[148:151], v18 offset:53248
    v_mfma_f32_32x32x16_bf16 v[104:119], v[156:159], v[140:143], v[104:119]
    ds_read_b64_tr_b16 v[172:173], v23 offset:2048
    ds_read_b64_tr_b16 v[174:175], v23 offset:2560
    s_waitcnt lgkmcnt(8)
    v_mfma_f32_32x32x16_bf16 v[72:87], v[136:139], v[160:163], v[72:87]
    v_mfma_f32_32x32x16_bf16 v[120:135], v[140:143], v[160:163], v[120:135]
    s_waitcnt lgkmcnt(0)
    s_barrier
    v_mfma_f32_32x32x16_bf16 v[40:55], v[164:167], v[144:147], v[40:55]
    ds_read_b128 v[136:139], v19 offset:49152
    ds_read_b64_tr_b16 v[152:153], v21 offset:16384
    v_mfma_f32_32x32x16_bf16 v[56:71], v[168:171], v[144:147], v[56:71]
    ds_read_b64_tr_b16 v[154:155], v21 offset:16896
    ds_read_b64_tr_b16 v[156:157], v22 offset:16384
    v_mfma_f32_32x32x16_bf16 v[88:103], v[164:167], v[148:151], v[88:103]
    ds_read_b64_tr_b16 v[158:159], v22 offset:16896
    ds_read_b128 v[140:143], v19 offset:53248
    v_mfma_f32_32x32x16_bf16 v[104:119], v[168:171], v[148:151], v[104:119]
    ds_read_b64_tr_b16 v[160:161], v23 offset:16384
    ds_read_b64_tr_b16 v[162:163], v23 offset:16896
    v_mfma_f32_32x32x16_bf16 v[72:87], v[144:147], v[172:175], v[72:87]
    v_mfma_f32_32x32x16_bf16 v[120:135], v[148:151], v[172:175], v[120:135]
    s_waitcnt lgkmcnt(5)
    v_mfma_f32_32x32x16_bf16 v[40:55], v[152:155], v[136:139], v[40:55]
    ds_read_b128 v[144:147], v20 offset:49152
    ds_read_b64_tr_b16 v[164:165], v21 offset:18432
    s_waitcnt lgkmcnt(5)
    v_mfma_f32_32x32x16_bf16 v[56:71], v[156:159], v[136:139], v[56:71]
    ds_read_b64_tr_b16 v[166:167], v21 offset:18944
    ds_read_b64_tr_b16 v[168:169], v22 offset:18432
    s_waitcnt lgkmcnt(6)
    v_mfma_f32_32x32x16_bf16 v[88:103], v[152:155], v[140:143], v[88:103]
    ds_read_b64_tr_b16 v[170:171], v22 offset:18944
    ds_read_b128 v[148:151], v20 offset:53248
    v_mfma_f32_32x32x16_bf16 v[104:119], v[156:159], v[140:143], v[104:119]
    ds_read_b64_tr_b16 v[172:173], v23 offset:18432
    ds_read_b64_tr_b16 v[174:175], v23 offset:18944
    s_waitcnt lgkmcnt(8)
    v_mfma_f32_32x32x16_bf16 v[72:87], v[136:139], v[160:163], v[72:87]
    v_mfma_f32_32x32x16_bf16 v[120:135], v[140:143], v[160:163], v[120:135]
    s_waitcnt lgkmcnt(0)
    s_barrier
    v_mfma_f32_32x32x16_bf16 v[40:55], v[164:167], v[144:147], v[40:55]
    ds_read_b128 v[136:139], v17 offset:0
    ds_read_b64_tr_b16 v[152:153], v21 offset:32768
    v_mfma_f32_32x32x16_bf16 v[56:71], v[168:171], v[144:147], v[56:71]
    ds_read_b64_tr_b16 v[154:155], v21 offset:33280
    ds_read_b64_tr_b16 v[156:157], v22 offset:32768
    v_mfma_f32_32x32x16_bf16 v[88:103], v[164:167], v[148:151], v[88:103]
    ds_read_b64_tr_b16 v[158:159], v22 offset:33280
    ds_read_b128 v[140:143], v17 offset:4096
    v_mfma_f32_32x32x16_bf16 v[104:119], v[168:171], v[148:151], v[104:119]
    ds_read_b64_tr_b16 v[160:161], v23 offset:32768
    ds_read_b64_tr_b16 v[162:163], v23 offset:33280
    v_mfma_f32_32x32x16_bf16 v[72:87], v[144:147], v[172:175], v[72:87]
    v_mfma_f32_32x32x16_bf16 v[120:135], v[148:151], v[172:175], v[120:135]
    s_waitcnt lgkmcnt(5)
    v_mfma_f32_32x32x16_bf16 v[40:55], v[152:155], v[136:139], v[40:55]
    ds_read_b128 v[144:147], v18 offset:0
    ds_read_b64_tr_b16 v[164:165], v21 offset:34816
    s_waitcnt lgkmcnt(5)
    v_mfma_f32_32x32x16_bf16 v[56:71], v[156:159], v[136:139], v[56:71]
    ds_read_b64_tr_b16 v[166:167], v21 offset:35328
    ds_read_b64_tr_b16 v[168:169], v22 offset:34816
    s_waitcnt lgkmcnt(6)
    v_mfma_f32_32x32x16_bf16 v[88:103], v[152:155], v[140:143], v[88:103]
    ds_read_b64_tr_b16 v[170:171], v22 offset:35328
    ds_read_b128 v[148:151], v18 offset:4096
    v_mfma_f32_32x32x16_bf16 v[104:119], v[156:159], v[140:143], v[104:119]
    ds_read_b64_tr_b16 v[172:173], v23 offset:34816
    ds_read_b64_tr_b16 v[174:175], v23 offset:35328
    s_waitcnt lgkmcnt(8)
    v_mfma_f32_32x32x16_bf16 v[72:87], v[136:139], v[160:163], v[72:87]
    v_mfma_f32_32x32x16_bf16 v[120:135], v[140:143], v[160:163], v[120:135]
    v_mov_b32 v36, 0
    buffer_load_dword v36, v36, s[20:23], 0 offen sc1
    s_waitcnt lgkmcnt(0)
    s_barrier
    v_mfma_f32_32x32x16_bf16 v[40:55], v[164:167], v[144:147], v[40:55]
    ds_read_b128 v[136:139], v19 offset:0
    ds_read_b64_tr_b16 v[152:153], v21 offset:49152
    v_mfma_f32_32x32x16_bf16 v[56:71], v[168:171], v[144:147], v[56:71]
    ds_read_b64_tr_b16 v[154:155], v21 offset:49664
    ds_read_b64_tr_b16 v[156:157], v22 offset:49152
    v_mfma_f32_32x32x16_bf16 v[88:103], v[164:167], v[148:151], v[88:103]
    ds_read_b64_tr_b16 v[158:159], v22 offset:49664
    ds_read_b128 v[140:143], v19 offset:4096
    v_mfma_f32_32x32x16_bf16 v[104:119], v[168:171], v[148:151], v[104:119]
    ds_read_b64_tr_b16 v[160:161], v23 offset:49152
    ds_read_b64_tr_b16 v[162:163], v23 offset:49664
    v_mfma_f32_32x32x16_bf16 v[72:87], v[144:147], v[172:175], v[72:87]
    v_mfma_f32_32x32x16_bf16 v[120:135], v[148:151], v[172:175], v[120:135]
    s_waitcnt lgkmcnt(5)
    v_mfma_f32_32x32x16_bf16 v[40:55], v[152:155], v[136:139], v[40:55]
    ds_read_b128 v[144:147], v20 offset:0
    ds_read_b64_tr_b16 v[164:165], v21 offset:51200
    s_waitcnt lgkmcnt(5)
    v_mfma_f32_32x32x16_bf16 v[56:71], v[156:159], v[136:139], v[56:71]
    ds_read_b64_tr_b16 v[166:167], v21 offset:51712
    ds_read_b64_tr_b16 v[168:169], v22 offset:51200
    s_waitcnt lgkmcnt(6)
    v_mfma_f32_32x32x16_bf16 v[88:103], v[152:155], v[140:143], v[88:103]
    ds_read_b64_tr_b16 v[170:171], v22 offset:51712
    ds_read_b128 v[148:151], v20 offset:4096
    v_mfma_f32_32x32x16_bf16 v[104:119], v[156:159], v[140:143], v[104:119]
    ds_read_b64_tr_b16 v[172:173], v23 offset:51200
    ds_read_b64_tr_b16 v[174:175], v23 offset:51712
    s_waitcnt lgkmcnt(8)
    v_mfma_f32_32x32x16_bf16 v[72:87], v[136:139], v[160:163], v[72:87]
    v_mfma_f32_32x32x16_bf16 v[120:135], v[140:143], v[160:163], v[120:135]
    s_waitcnt lgkmcnt(0)
    s_barrier
    v_mfma_f32_32x32x16_bf16 v[40:55], v[164:167], v[144:147], v[40:55]
    ds_read_b128 v[136:139], v17 offset:16384
    ds_read_b64_tr_b16 v[152:153], v24 offset:0
    v_mfma_f32_32x32x16_bf16 v[56:71], v[168:171], v[144:147], v[56:71]
    ds_read_b64_tr_b16 v[154:155], v24 offset:512
    ds_read_b64_tr_b16 v[156:157], v25 offset:0
    v_mfma_f32_32x32x16_bf16 v[88:103], v[164:167], v[148:151], v[88:103]
    ds_read_b64_tr_b16 v[158:159], v25 offset:512
    ds_read_b128 v[140:143], v17 offset:20480
    v_mfma_f32_32x32x16_bf16 v[104:119], v[168:171], v[148:151], v[104:119]
    ds_read_b64_tr_b16 v[160:161], v26 offset:0
    ds_read_b64_tr_b16 v[162:163], v26 offset:512
    v_mfma_f32_32x32x16_bf16 v[72:87], v[144:147], v[172:175], v[72:87]
    v_mfma_f32_32x32x16_bf16 v[120:135], v[148:151], v[172:175], v[120:135]
    s_waitcnt lgkmcnt(5)
    v_mfma_f32_32x32x16_bf16 v[40:55], v[152:155], v[136:139], v[40:55]
    ds_read_b128 v[144:147], v18 offset:16384
    ds_read_b64_tr_b16 v[164:165], v24 offset:2048
    s_waitcnt lgkmcnt(5)
    v_mfma_f32_32x32x16_bf16 v[56:71], v[156:159], v[136:139], v[56:71]
    ds_read_b64_tr_b16 v[166:167], v24 offset:2560
    ds_read_b64_tr_b16 v[168:169], v25 offset:2048
    s_waitcnt lgkmcnt(6)
    v_mfma_f32_32x32x16_bf16 v[88:103], v[152:155], v[140:143], v[88:103]
    ds_read_b64_tr_b16 v[170:171], v25 offset:2560
    ds_read_b128 v[148:151], v18 offset:20480
    v_mfma_f32_32x32x16_bf16 v[104:119], v[156:159], v[140:143], v[104:119]
    ds_read_b64_tr_b16 v[172:173], v26 offset:2048
    ds_read_b64_tr_b16 v[174:175], v26 offset:2560
    s_waitcnt lgkmcnt(8)
    v_mfma_f32_32x32x16_bf16 v[72:87], v[136:139], v[160:163], v[72:87]
    v_mfma_f32_32x32x16_bf16 v[120:135], v[140:143], v[160:163], v[120:135]
    s_waitcnt lgkmcnt(0)
    s_barrier
    v_mfma_f32_32x32x16_bf16 v[40:55], v[164:167], v[144:147], v[40:55]
    ds_read_b128 v[136:139], v19 offset:16384
    ds_read_b64_tr_b16 v[152:153], v24 offset:16384
    v_mfma_f32_32x32x16_bf16 v[56:71], v[168:171], v[144:147], v[56:71]
    ds_read_b64_tr_b16 v[154:155], v24 offset:16896
    ds_read_b64_tr_b16 v[156:157], v25 offset:16384
    v_mfma_f32_32x32x16_bf16 v[88:103], v[164:167], v[148:151], v[88:103]
    ds_read_b64_tr_b16 v[158:159], v25 offset:16896
    ds_read_b128 v[140:143], v19 offset:20480
    v_mfma_f32_32x32x16_bf16 v[104:119], v[168:171], v[148:151], v[104:119]
    ds_read_b64_tr_b16 v[160:161], v26 offset:16384
    ds_read_b64_tr_b16 v[162:163], v26 offset:16896
    v_mfma_f32_32x32x16_bf16 v[72:87], v[144:147], v[172:175], v[72:87]
    v_mfma_f32_32x32x16_bf16 v[120:135], v[148:151], v[172:175], v[120:135]
    s_waitcnt lgkmcnt(5)
    v_mfma_f32_32x32x16_bf16 v[40:55], v[152:155], v[136:139], v[40:55]
    ds_read_b128 v[144:147], v20 offset:16384
    ds_read_b64_tr_b16 v[164:165], v24 offset:18432
    s_waitcnt lgkmcnt(5)
    v_mfma_f32_32x32x16_bf16 v[56:71], v[156:159], v[136:139], v[56:71]
    ds_read_b64_tr_b16 v[166:167], v24 offset:18944
    ds_read_b64_tr_b16 v[168:169], v25 offset:18432
    s_waitcnt lgkmcnt(6)
    v_mfma_f32_32x32x16_bf16 v[88:103], v[152:155], v[140:143], v[88:103]
    ds_read_b64_tr_b16 v[170:171], v25 offset:18944
    ds_read_b128 v[148:151], v20 offset:20480
    v_mfma_f32_32x32x16_bf16 v[104:119], v[156:159], v[140:143], v[104:119]
    ds_read_b64_tr_b16 v[172:173], v26 offset:18432
    ds_read_b64_tr_b16 v[174:175], v26 offset:18944
    s_waitcnt lgkmcnt(8)
    v_mfma_f32_32x32x16_bf16 v[72:87], v[136:139], v[160:163], v[72:87]
    v_mfma_f32_32x32x16_bf16 v[120:135], v[140:143], v[160:163], v[120:135]
    s_waitcnt lgkmcnt(0)
    s_barrier
    v_mfma_f32_32x32x16_bf16 v[40:55], v[164:167], v[144:147], v[40:55]
    ds_read_b128 v[192:195], v17 offset:32768
    ds_read_b128 v[196:199], v18 offset:32768
    v_mfma_f32_32x32x16_bf16 v[56:71], v[168:171], v[144:147], v[56:71]
    ds_read_b128 v[200:203], v19 offset:32768
    ds_read_b128 v[204:207], v20 offset:32768
    v_mfma_f32_32x32x16_bf16 v[88:103], v[164:167], v[148:151], v[88:103]
    ds_read_b64_tr_b16 v[208:209], v21 offset:0
    ds_read_b64_tr_b16 v[210:211], v21 offset:512
    v_mfma_f32_32x32x16_bf16 v[104:119], v[168:171], v[148:151], v[104:119]
    ds_read_b64_tr_b16 v[212:213], v21 offset:2048
    ds_read_b64_tr_b16 v[214:215], v21 offset:2560
    v_mfma_f32_32x32x16_bf16 v[72:87], v[144:147], v[172:175], v[72:87]
    ds_read_b64_tr_b16 v[216:217], v21 offset:16384
    ds_read_b64_tr_b16 v[218:219], v21 offset:16896
    v_mfma_f32_32x32x16_bf16 v[120:135], v[148:151], v[172:175], v[120:135]
    ds_read_b64_tr_b16 v[220:221], v21 offset:18432
    ds_read_b64_tr_b16 v[222:223], v21 offset:18944
    s_waitcnt lgkmcnt(0)
    ds_read_b128 v[136:139], v17 offset:36864
    ds_read_b128 v[140:143], v18 offset:36864
    v_mfma_f32_32x32x16_bf16 v[40:55], v[208:211], v[192:195], v[40:55]
    ds_read_b128 v[144:147], v19 offset:36864
    ds_read_b128 v[148:151], v20 offset:36864
    v_mfma_f32_32x32x16_bf16 v[40:55], v[212:215], v[196:199], v[40:55]
    v_mfma_f32_32x32x16_bf16 v[40:55], v[216:219], v[200:203], v[40:55]
    v_mfma_f32_32x32x16_bf16 v[40:55], v[220:223], v[204:207], v[40:55]
    s_waitcnt lgkmcnt(0)
    ds_read_b64_tr_b16 v[152:153], v22 offset:0
    ds_read_b64_tr_b16 v[154:155], v22 offset:512
    v_mfma_f32_32x32x16_bf16 v[88:103], v[208:211], v[136:139], v[88:103]
    ds_read_b64_tr_b16 v[156:157], v22 offset:2048
    ds_read_b64_tr_b16 v[158:159], v22 offset:2560
    v_mfma_f32_32x32x16_bf16 v[88:103], v[212:215], v[140:143], v[88:103]
    s_nop 4
    v_pk_mul_f32 v[40:41], v[40:41], s[4:5]
    v_pk_mul_f32 v[42:43], v[42:43], s[4:5]
    v_pk_mul_f32 v[44:45], v[44:45], s[4:5]
    v_pk_mul_f32 v[46:47], v[46:47], s[4:5]
    v_pk_mul_f32 v[48:49], v[48:49], s[4:5]
    v_pk_mul_f32 v[50:51], v[50:51], s[4:5]
    v_pk_mul_f32 v[52:53], v[52:53], s[4:5]
    ds_read_b64_tr_b16 v[160:161], v22 offset:16384
    ds_read_b64_tr_b16 v[162:163], v22 offset:16896
    v_mfma_f32_32x32x16_bf16 v[88:103], v[216:219], v[144:147], v[88:103]
    v_pk_mul_f32 v[54:55], v[54:55], s[4:5]
    v_cvt_pk_bf16_f32 v176, v40, v41
    v_cvt_pk_bf16_f32 v177, v42, v43
    v_cvt_pk_bf16_f32 v178, v44, v45
    v_cvt_pk_bf16_f32 v179, v46, v47
    v_cvt_pk_bf16_f32 v180, v48, v49
    v_cvt_pk_bf16_f32 v181, v50, v51
    ds_read_b64_tr_b16 v[164:165], v22 offset:18432
    ds_read_b64_tr_b16 v[166:167], v22 offset:18944
    v_mfma_f32_32x32x16_bf16 v[88:103], v[220:223], v[148:151], v[88:103]
    v_cvt_pk_bf16_f32 v182, v52, v53
    v_cvt_pk_bf16_f32 v183, v54, v55
    s_mov_b64 exec, s[34:35]
    v_mov_b32 v182, 1065369472
    v_mov_b32 v183, 0x00003f80
    s_mov_b64 exec, -1
    buffer_store_dwordx4 v[176:179], v27, s[8:11], s66 offen offset:0 sc1
    buffer_store_dwordx4 v[180:183], v27, s[8:11], s66 offen offset:1024 sc1
    s_waitcnt lgkmcnt(0)
    ds_read_b64_tr_b16 v[168:169], v23 offset:0
    ds_read_b64_tr_b16 v[170:171], v23 offset:512
    v_mfma_f32_32x32x16_bf16 v[56:71], v[152:155], v[192:195], v[56:71]
    ds_read_b64_tr_b16 v[172:173], v23 offset:2048
    ds_read_b64_tr_b16 v[174:175], v23 offset:2560
    v_mfma_f32_32x32x16_bf16 v[56:71], v[156:159], v[196:199], v[56:71]
    v_pk_mul_f32 v[88:89], v[88:89], s[4:5]
    v_pk_mul_f32 v[90:91], v[90:91], s[4:5]
    v_pk_mul_f32 v[92:93], v[92:93], s[4:5]
    v_pk_mul_f32 v[94:95], v[94:95], s[4:5]
    v_pk_mul_f32 v[96:97], v[96:97], s[4:5]
    v_pk_mul_f32 v[98:99], v[98:99], s[4:5]
    v_pk_mul_f32 v[100:101], v[100:101], s[4:5]
    ds_read_b64_tr_b16 v[224:225], v23 offset:16384
    ds_read_b64_tr_b16 v[226:227], v23 offset:16896
    v_mfma_f32_32x32x16_bf16 v[56:71], v[160:163], v[200:203], v[56:71]
    v_pk_mul_f32 v[102:103], v[102:103], s[4:5]
    v_cvt_pk_bf16_f32 v184, v88, v89
    v_cvt_pk_bf16_f32 v185, v90, v91
    v_cvt_pk_bf16_f32 v186, v92, v93
    v_cvt_pk_bf16_f32 v187, v94, v95
    v_cvt_pk_bf16_f32 v188, v96, v97
    v_cvt_pk_bf16_f32 v189, v98, v99
    ds_read_b64_tr_b16 v[228:229], v23 offset:18432
    ds_read_b64_tr_b16 v[230:231], v23 offset:18944
    v_mfma_f32_32x32x16_bf16 v[56:71], v[164:167], v[204:207], v[56:71]
    v_cvt_pk_bf16_f32 v190, v100, v101
    v_cvt_pk_bf16_f32 v191, v102, v103
    s_mov_b64 exec, s[34:35]
    v_mov_b32 v190, 1065369472
    v_mov_b32 v191, 0x00003f80
    s_mov_b64 exec, -1
    buffer_store_dwordx4 v[184:187], v27, s[8:11], s66 offen offset:2048 sc1
    buffer_store_dwordx4 v[188:191], v27, s[8:11], s66 offen offset:3072 sc1
    s_waitcnt lgkmcnt(0)
    v_mfma_f32_32x32x16_bf16 v[104:119], v[152:155], v[136:139], v[104:119]
    v_mfma_f32_32x32x16_bf16 v[104:119], v[156:159], v[140:143], v[104:119]
    s_nop 0
    v_pk_mul_f32 v[56:57], v[56:57], s[6:7]
    v_pk_mul_f32 v[58:59], v[58:59], s[6:7]
    v_pk_mul_f32 v[60:61], v[60:61], s[6:7]
    v_pk_mul_f32 v[62:63], v[62:63], s[6:7]
    v_pk_mul_f32 v[64:65], v[64:65], s[6:7]
    v_pk_mul_f32 v[66:67], v[66:67], s[6:7]
    v_pk_mul_f32 v[68:69], v[68:69], s[6:7]
    v_mfma_f32_32x32x16_bf16 v[104:119], v[160:163], v[144:147], v[104:119]
    v_pk_mul_f32 v[70:71], v[70:71], s[6:7]
    v_cvt_pk_bf16_f32 v176, v56, v57
    v_cvt_pk_bf16_f32 v177, v58, v59
    v_cvt_pk_bf16_f32 v178, v60, v61
    v_cvt_pk_bf16_f32 v179, v62, v63
    v_cvt_pk_bf16_f32 v180, v64, v65
    v_cvt_pk_bf16_f32 v181, v66, v67
    v_mfma_f32_32x32x16_bf16 v[104:119], v[164:167], v[148:151], v[104:119]
    v_cvt_pk_bf16_f32 v182, v68, v69
    v_cvt_pk_bf16_f32 v183, v70, v71
    s_mov_b64 exec, s[34:35]
    v_mov_b32 v182, 1065369472
    v_mov_b32 v183, 0x00003f80
    s_mov_b64 exec, -1
    buffer_store_dwordx4 v[176:179], v27, s[8:11], s67 offen offset:0 sc1
    buffer_store_dwordx4 v[180:183], v27, s[8:11], s67 offen offset:1024 sc1
    s_waitcnt lgkmcnt(0)
    v_mfma_f32_32x32x16_bf16 v[72:87], v[192:195], v[168:171], v[72:87]
    v_mfma_f32_32x32x16_bf16 v[72:87], v[196:199], v[172:175], v[72:87]
    s_nop 0
    v_pk_mul_f32 v[104:105], v[104:105], s[6:7]
    v_pk_mul_f32 v[106:107], v[106:107], s[6:7]
    v_pk_mul_f32 v[108:109], v[108:109], s[6:7]
    v_pk_mul_f32 v[110:111], v[110:111], s[6:7]
    v_pk_mul_f32 v[112:113], v[112:113], s[6:7]
    v_pk_mul_f32 v[114:115], v[114:115], s[6:7]
    v_pk_mul_f32 v[116:117], v[116:117], s[6:7]
    v_mfma_f32_32x32x16_bf16 v[72:87], v[200:203], v[224:227], v[72:87]
    v_pk_mul_f32 v[118:119], v[118:119], s[6:7]
    v_cvt_pk_bf16_f32 v184, v104, v105
    v_cvt_pk_bf16_f32 v185, v106, v107
    v_cvt_pk_bf16_f32 v186, v108, v109
    v_cvt_pk_bf16_f32 v187, v110, v111
    v_cvt_pk_bf16_f32 v188, v112, v113
    v_cvt_pk_bf16_f32 v189, v114, v115
    v_mfma_f32_32x32x16_bf16 v[72:87], v[204:207], v[228:231], v[72:87]
    v_cvt_pk_bf16_f32 v190, v116, v117
    v_cvt_pk_bf16_f32 v191, v118, v119
    s_mov_b64 exec, s[34:35]
    v_mov_b32 v190, 1065369472
    v_mov_b32 v191, 0x00003f80
    s_mov_b64 exec, -1
    buffer_store_dwordx4 v[184:187], v27, s[8:11], s67 offen offset:2048 sc1
    buffer_store_dwordx4 v[188:191], v27, s[8:11], s67 offen offset:3072 sc1
    s_waitcnt lgkmcnt(0)
    v_mfma_f32_32x32x16_bf16 v[120:135], v[136:139], v[168:171], v[120:135]
    v_mfma_f32_32x32x16_bf16 v[120:135], v[140:143], v[172:175], v[120:135]
    s_nop 0
    v_cvt_pk_bf16_f32 v176, v72, v73
    v_cvt_pk_bf16_f32 v177, v74, v75
    v_cvt_pk_bf16_f32 v178, v76, v77
    v_cvt_pk_bf16_f32 v179, v78, v79
    v_cvt_pk_bf16_f32 v180, v80, v81
    v_cvt_pk_bf16_f32 v181, v82, v83
    v_cvt_pk_bf16_f32 v182, v84, v85
    v_mfma_f32_32x32x16_bf16 v[120:135], v[144:147], v[224:227], v[120:135]
    v_cvt_pk_bf16_f32 v183, v86, v87
    s_mov_b32 exec_lo, 0xf0000000
    s_mov_b32 exec_hi, 0xf0000000
    v_mov_b32 v176, v35
    v_mov_b32 v177, v35
    v_mov_b32 v178, v35
    v_mov_b32 v179, v35
    v_mov_b32 v180, v35
    v_mov_b32 v181, v35
    v_mov_b32 v182, v35
    v_mov_b32 v183, v35
    s_mov_b64 exec, -1
    buffer_store_dwordx4 v[176:179], v27, s[8:11], s33 offen offset:0 sc1
    buffer_store_dwordx4 v[180:183], v27, s[8:11], s33 offen offset:1024 sc1
    v_mfma_f32_32x32x16_bf16 v[120:135], v[148:151], v[228:231], v[120:135]
    s_nop 11
    v_cvt_pk_bf16_f32 v184, v120, v121
    v_cvt_pk_bf16_f32 v185, v122, v123
    v_cvt_pk_bf16_f32 v186, v124, v125
    v_cvt_pk_bf16_f32 v187, v126, v127
    v_cvt_pk_bf16_f32 v188, v128, v129
    v_cvt_pk_bf16_f32 v189, v130, v131
    v_cvt_pk_bf16_f32 v190, v132, v133
    v_cvt_pk_bf16_f32 v191, v134, v135
    s_mov_b32 exec_lo, 0xf0000000
    s_mov_b32 exec_hi, 0xf0000000
    v_mov_b32 v184, v35
    v_mov_b32 v185, v35
    v_mov_b32 v186, v35
    v_mov_b32 v187, v35
    v_mov_b32 v188, v35
    v_mov_b32 v189, v35
    v_mov_b32 v190, v35
    v_mov_b32 v191, v35
    s_mov_b64 exec, -1
    buffer_store_dwordx4 v[184:187], v27, s[8:11], s33 offen offset:2048 sc1
    buffer_store_dwordx4 v[188:191], v27, s[8:11], s33 offen offset:3072 sc1
    s_waitcnt vmcnt(0)
    s_branch concat_heads__linear_kernel_hedgehog__mha_block__prompt_kernel_p1_end
concat_heads__linear_kernel_hedgehog__mha_block__prompt_kernel_NNN:
    s_add_u32 s66, s63, 0
    s_add_u32 s67, s63, 131072
    s_add_u32 s33, s63, 262144
    s_barrier
    ds_read_b128 v[136:139], v17 offset:0
    ds_read_b64_tr_b16 v[152:153], v21 offset:0
    ds_read_b64_tr_b16 v[154:155], v21 offset:512
    ds_read_b64_tr_b16 v[156:157], v22 offset:0
    ds_read_b64_tr_b16 v[158:159], v22 offset:512
    ds_read_b128 v[140:143], v17 offset:4096
    ds_read_b64_tr_b16 v[160:161], v23 offset:0
    ds_read_b64_tr_b16 v[162:163], v23 offset:512
    s_waitcnt lgkmcnt(5)
    v_mfma_f32_32x32x16_bf16 v[40:55], v[136:139], v[152:155], 0
    ds_read_b128 v[144:147], v18 offset:0
    ds_read_b64_tr_b16 v[164:165], v21 offset:2048
    s_waitcnt lgkmcnt(5)
    v_mfma_f32_32x32x16_bf16 v[56:71], v[136:139], v[156:159], 0
    ds_read_b64_tr_b16 v[166:167], v21 offset:2560
    ds_read_b64_tr_b16 v[168:169], v22 offset:2048
    s_waitcnt lgkmcnt(6)
    v_mfma_f32_32x32x16_bf16 v[88:103], v[140:143], v[152:155], 0
    ds_read_b64_tr_b16 v[170:171], v22 offset:2560
    ds_read_b128 v[148:151], v18 offset:4096
    v_mfma_f32_32x32x16_bf16 v[104:119], v[140:143], v[156:159], 0
    ds_read_b64_tr_b16 v[172:173], v23 offset:2048
    ds_read_b64_tr_b16 v[174:175], v23 offset:2560
    s_waitcnt lgkmcnt(8)
    v_mfma_f32_32x32x16_bf16 v[72:87], v[136:139], v[160:163], 0
    v_mfma_f32_32x32x16_bf16 v[120:135], v[140:143], v[160:163], 0
    s_waitcnt lgkmcnt(0)
    s_barrier
    v_mfma_f32_32x32x16_bf16 v[40:55], v[144:147], v[164:167], v[40:55]
    ds_read_b128 v[136:139], v19 offset:0
    ds_read_b64_tr_b16 v[152:153], v21 offset:16384
    v_mfma_f32_32x32x16_bf16 v[56:71], v[144:147], v[168:171], v[56:71]
    ds_read_b64_tr_b16 v[154:155], v21 offset:16896
    ds_read_b64_tr_b16 v[156:157], v22 offset:16384
    v_mfma_f32_32x32x16_bf16 v[88:103], v[148:151], v[164:167], v[88:103]
    ds_read_b64_tr_b16 v[158:159], v22 offset:16896
    ds_read_b128 v[140:143], v19 offset:4096
    v_mfma_f32_32x32x16_bf16 v[104:119], v[148:151], v[168:171], v[104:119]
    ds_read_b64_tr_b16 v[160:161], v23 offset:16384
    ds_read_b64_tr_b16 v[162:163], v23 offset:16896
    v_mfma_f32_32x32x16_bf16 v[72:87], v[144:147], v[172:175], v[72:87]
    v_mfma_f32_32x32x16_bf16 v[120:135], v[148:151], v[172:175], v[120:135]
    s_waitcnt lgkmcnt(5)
    v_mfma_f32_32x32x16_bf16 v[40:55], v[136:139], v[152:155], v[40:55]
    ds_read_b128 v[144:147], v20 offset:0
    ds_read_b64_tr_b16 v[164:165], v21 offset:18432
    s_waitcnt lgkmcnt(5)
    v_mfma_f32_32x32x16_bf16 v[56:71], v[136:139], v[156:159], v[56:71]
    ds_read_b64_tr_b16 v[166:167], v21 offset:18944
    ds_read_b64_tr_b16 v[168:169], v22 offset:18432
    s_waitcnt lgkmcnt(6)
    v_mfma_f32_32x32x16_bf16 v[88:103], v[140:143], v[152:155], v[88:103]
    ds_read_b64_tr_b16 v[170:171], v22 offset:18944
    ds_read_b128 v[148:151], v20 offset:4096
    v_mfma_f32_32x32x16_bf16 v[104:119], v[140:143], v[156:159], v[104:119]
    ds_read_b64_tr_b16 v[172:173], v23 offset:18432
    ds_read_b64_tr_b16 v[174:175], v23 offset:18944
    s_waitcnt lgkmcnt(8)
    v_mfma_f32_32x32x16_bf16 v[72:87], v[136:139], v[160:163], v[72:87]
    v_mfma_f32_32x32x16_bf16 v[120:135], v[140:143], v[160:163], v[120:135]
    s_waitcnt lgkmcnt(0)
    s_barrier
    v_mfma_f32_32x32x16_bf16 v[40:55], v[144:147], v[164:167], v[40:55]
    ds_read_b128 v[136:139], v17 offset:16384
    ds_read_b64_tr_b16 v[152:153], v21 offset:32768
    v_mfma_f32_32x32x16_bf16 v[56:71], v[144:147], v[168:171], v[56:71]
    ds_read_b64_tr_b16 v[154:155], v21 offset:33280
    ds_read_b64_tr_b16 v[156:157], v22 offset:32768
    v_mfma_f32_32x32x16_bf16 v[88:103], v[148:151], v[164:167], v[88:103]
    ds_read_b64_tr_b16 v[158:159], v22 offset:33280
    ds_read_b128 v[140:143], v17 offset:20480
    v_mfma_f32_32x32x16_bf16 v[104:119], v[148:151], v[168:171], v[104:119]
    ds_read_b64_tr_b16 v[160:161], v23 offset:32768
    ds_read_b64_tr_b16 v[162:163], v23 offset:33280
    v_mfma_f32_32x32x16_bf16 v[72:87], v[144:147], v[172:175], v[72:87]
    v_mfma_f32_32x32x16_bf16 v[120:135], v[148:151], v[172:175], v[120:135]
    s_waitcnt lgkmcnt(5)
    v_mfma_f32_32x32x16_bf16 v[40:55], v[136:139], v[152:155], v[40:55]
    ds_read_b128 v[144:147], v18 offset:16384
    ds_read_b64_tr_b16 v[164:165], v21 offset:34816
    s_waitcnt lgkmcnt(5)
    v_mfma_f32_32x32x16_bf16 v[56:71], v[136:139], v[156:159], v[56:71]
    ds_read_b64_tr_b16 v[166:167], v21 offset:35328
    ds_read_b64_tr_b16 v[168:169], v22 offset:34816
    s_waitcnt lgkmcnt(6)
    v_mfma_f32_32x32x16_bf16 v[88:103], v[140:143], v[152:155], v[88:103]
    ds_read_b64_tr_b16 v[170:171], v22 offset:35328
    ds_read_b128 v[148:151], v18 offset:20480
    v_mfma_f32_32x32x16_bf16 v[104:119], v[140:143], v[156:159], v[104:119]
    ds_read_b64_tr_b16 v[172:173], v23 offset:34816
    ds_read_b64_tr_b16 v[174:175], v23 offset:35328
    s_waitcnt lgkmcnt(8)
    v_mfma_f32_32x32x16_bf16 v[72:87], v[136:139], v[160:163], v[72:87]
    v_mfma_f32_32x32x16_bf16 v[120:135], v[140:143], v[160:163], v[120:135]
    s_waitcnt lgkmcnt(0)
    s_barrier
    v_mfma_f32_32x32x16_bf16 v[40:55], v[144:147], v[164:167], v[40:55]
    ds_read_b128 v[136:139], v19 offset:16384
    ds_read_b64_tr_b16 v[152:153], v21 offset:49152
    v_mfma_f32_32x32x16_bf16 v[56:71], v[144:147], v[168:171], v[56:71]
    ds_read_b64_tr_b16 v[154:155], v21 offset:49664
    ds_read_b64_tr_b16 v[156:157], v22 offset:49152
    v_mfma_f32_32x32x16_bf16 v[88:103], v[148:151], v[164:167], v[88:103]
    ds_read_b64_tr_b16 v[158:159], v22 offset:49664
    ds_read_b128 v[140:143], v19 offset:20480
    v_mfma_f32_32x32x16_bf16 v[104:119], v[148:151], v[168:171], v[104:119]
    ds_read_b64_tr_b16 v[160:161], v23 offset:49152
    ds_read_b64_tr_b16 v[162:163], v23 offset:49664
    v_mfma_f32_32x32x16_bf16 v[72:87], v[144:147], v[172:175], v[72:87]
    v_mfma_f32_32x32x16_bf16 v[120:135], v[148:151], v[172:175], v[120:135]
    s_waitcnt lgkmcnt(5)
    v_mfma_f32_32x32x16_bf16 v[40:55], v[136:139], v[152:155], v[40:55]
    ds_read_b128 v[144:147], v20 offset:16384
    ds_read_b64_tr_b16 v[164:165], v21 offset:51200
    s_waitcnt lgkmcnt(5)
    v_mfma_f32_32x32x16_bf16 v[56:71], v[136:139], v[156:159], v[56:71]
    ds_read_b64_tr_b16 v[166:167], v21 offset:51712
    ds_read_b64_tr_b16 v[168:169], v22 offset:51200
    s_waitcnt lgkmcnt(6)
    v_mfma_f32_32x32x16_bf16 v[88:103], v[140:143], v[152:155], v[88:103]
    ds_read_b64_tr_b16 v[170:171], v22 offset:51712
    ds_read_b128 v[148:151], v20 offset:20480
    v_mfma_f32_32x32x16_bf16 v[104:119], v[140:143], v[156:159], v[104:119]
    ds_read_b64_tr_b16 v[172:173], v23 offset:51200
    ds_read_b64_tr_b16 v[174:175], v23 offset:51712
    s_waitcnt lgkmcnt(8)
    v_mfma_f32_32x32x16_bf16 v[72:87], v[136:139], v[160:163], v[72:87]
    v_mfma_f32_32x32x16_bf16 v[120:135], v[140:143], v[160:163], v[120:135]
    s_waitcnt lgkmcnt(0)
    s_barrier
    v_mfma_f32_32x32x16_bf16 v[40:55], v[144:147], v[164:167], v[40:55]
    ds_read_b128 v[136:139], v17 offset:32768
    ds_read_b64_tr_b16 v[152:153], v24 offset:0
    v_mfma_f32_32x32x16_bf16 v[56:71], v[144:147], v[168:171], v[56:71]
    ds_read_b64_tr_b16 v[154:155], v24 offset:512
    ds_read_b64_tr_b16 v[156:157], v25 offset:0
    v_mfma_f32_32x32x16_bf16 v[88:103], v[148:151], v[164:167], v[88:103]
    ds_read_b64_tr_b16 v[158:159], v25 offset:512
    ds_read_b128 v[140:143], v17 offset:36864
    v_mfma_f32_32x32x16_bf16 v[104:119], v[148:151], v[168:171], v[104:119]
    ds_read_b64_tr_b16 v[160:161], v26 offset:0
    ds_read_b64_tr_b16 v[162:163], v26 offset:512
    v_mfma_f32_32x32x16_bf16 v[72:87], v[144:147], v[172:175], v[72:87]
    v_mfma_f32_32x32x16_bf16 v[120:135], v[148:151], v[172:175], v[120:135]
    s_waitcnt lgkmcnt(5)
    v_mfma_f32_32x32x16_bf16 v[40:55], v[136:139], v[152:155], v[40:55]
    ds_read_b128 v[144:147], v18 offset:32768
    ds_read_b64_tr_b16 v[164:165], v24 offset:2048
    s_waitcnt lgkmcnt(5)
    v_mfma_f32_32x32x16_bf16 v[56:71], v[136:139], v[156:159], v[56:71]
    ds_read_b64_tr_b16 v[166:167], v24 offset:2560
    ds_read_b64_tr_b16 v[168:169], v25 offset:2048
    s_waitcnt lgkmcnt(6)
    v_mfma_f32_32x32x16_bf16 v[88:103], v[140:143], v[152:155], v[88:103]
    ds_read_b64_tr_b16 v[170:171], v25 offset:2560
    ds_read_b128 v[148:151], v18 offset:36864
    v_mfma_f32_32x32x16_bf16 v[104:119], v[140:143], v[156:159], v[104:119]
    ds_read_b64_tr_b16 v[172:173], v26 offset:2048
    ds_read_b64_tr_b16 v[174:175], v26 offset:2560
    s_waitcnt lgkmcnt(8)
    v_mfma_f32_32x32x16_bf16 v[72:87], v[136:139], v[160:163], v[72:87]
    v_mfma_f32_32x32x16_bf16 v[120:135], v[140:143], v[160:163], v[120:135]
    s_waitcnt lgkmcnt(0)
    s_barrier
    v_mfma_f32_32x32x16_bf16 v[40:55], v[144:147], v[164:167], v[40:55]
    ds_read_b128 v[136:139], v19 offset:32768
    ds_read_b64_tr_b16 v[152:153], v24 offset:16384
    v_mfma_f32_32x32x16_bf16 v[56:71], v[144:147], v[168:171], v[56:71]
    ds_read_b64_tr_b16 v[154:155], v24 offset:16896
    ds_read_b64_tr_b16 v[156:157], v25 offset:16384
    v_mfma_f32_32x32x16_bf16 v[88:103], v[148:151], v[164:167], v[88:103]
    ds_read_b64_tr_b16 v[158:159], v25 offset:16896
    ds_read_b128 v[140:143], v19 offset:36864
    v_mfma_f32_32x32x16_bf16 v[104:119], v[148:151], v[168:171], v[104:119]
    ds_read_b64_tr_b16 v[160:161], v26 offset:16384
    ds_read_b64_tr_b16 v[162:163], v26 offset:16896
    v_mfma_f32_32x32x16_bf16 v[72:87], v[144:147], v[172:175], v[72:87]
    v_mfma_f32_32x32x16_bf16 v[120:135], v[148:151], v[172:175], v[120:135]
    s_waitcnt lgkmcnt(5)
    v_mfma_f32_32x32x16_bf16 v[40:55], v[136:139], v[152:155], v[40:55]
    ds_read_b128 v[144:147], v20 offset:32768
    ds_read_b64_tr_b16 v[164:165], v24 offset:18432
    s_waitcnt lgkmcnt(5)
    v_mfma_f32_32x32x16_bf16 v[56:71], v[136:139], v[156:159], v[56:71]
    ds_read_b64_tr_b16 v[166:167], v24 offset:18944
    ds_read_b64_tr_b16 v[168:169], v25 offset:18432
    s_waitcnt lgkmcnt(6)
    v_mfma_f32_32x32x16_bf16 v[88:103], v[140:143], v[152:155], v[88:103]
    ds_read_b64_tr_b16 v[170:171], v25 offset:18944
    ds_read_b128 v[148:151], v20 offset:36864
    v_mfma_f32_32x32x16_bf16 v[104:119], v[140:143], v[156:159], v[104:119]
    ds_read_b64_tr_b16 v[172:173], v26 offset:18432
    ds_read_b64_tr_b16 v[174:175], v26 offset:18944
    s_waitcnt lgkmcnt(8)
    v_mfma_f32_32x32x16_bf16 v[72:87], v[136:139], v[160:163], v[72:87]
    v_mfma_f32_32x32x16_bf16 v[120:135], v[140:143], v[160:163], v[120:135]
    s_waitcnt lgkmcnt(0)
    s_barrier
    v_mfma_f32_32x32x16_bf16 v[40:55], v[144:147], v[164:167], v[40:55]
    ds_read_b128 v[136:139], v17 offset:49152
    ds_read_b64_tr_b16 v[152:153], v21 offset:0
    v_mfma_f32_32x32x16_bf16 v[56:71], v[144:147], v[168:171], v[56:71]
    ds_read_b64_tr_b16 v[154:155], v21 offset:512
    ds_read_b64_tr_b16 v[156:157], v22 offset:0
    v_mfma_f32_32x32x16_bf16 v[88:103], v[148:151], v[164:167], v[88:103]
    ds_read_b64_tr_b16 v[158:159], v22 offset:512
    ds_read_b128 v[140:143], v17 offset:53248
    v_mfma_f32_32x32x16_bf16 v[104:119], v[148:151], v[168:171], v[104:119]
    ds_read_b64_tr_b16 v[160:161], v23 offset:0
    ds_read_b64_tr_b16 v[162:163], v23 offset:512
    v_mfma_f32_32x32x16_bf16 v[72:87], v[144:147], v[172:175], v[72:87]
    v_mfma_f32_32x32x16_bf16 v[120:135], v[148:151], v[172:175], v[120:135]
    s_waitcnt lgkmcnt(5)
    v_mfma_f32_32x32x16_bf16 v[40:55], v[136:139], v[152:155], v[40:55]
    ds_read_b128 v[144:147], v18 offset:49152
    ds_read_b64_tr_b16 v[164:165], v21 offset:2048
    s_waitcnt lgkmcnt(5)
    v_mfma_f32_32x32x16_bf16 v[56:71], v[136:139], v[156:159], v[56:71]
    ds_read_b64_tr_b16 v[166:167], v21 offset:2560
    ds_read_b64_tr_b16 v[168:169], v22 offset:2048
    s_waitcnt lgkmcnt(6)
    v_mfma_f32_32x32x16_bf16 v[88:103], v[140:143], v[152:155], v[88:103]
    ds_read_b64_tr_b16 v[170:171], v22 offset:2560
    ds_read_b128 v[148:151], v18 offset:53248
    v_mfma_f32_32x32x16_bf16 v[104:119], v[140:143], v[156:159], v[104:119]
    ds_read_b64_tr_b16 v[172:173], v23 offset:2048
    ds_read_b64_tr_b16 v[174:175], v23 offset:2560
    s_waitcnt lgkmcnt(8)
    v_mfma_f32_32x32x16_bf16 v[72:87], v[136:139], v[160:163], v[72:87]
    v_mfma_f32_32x32x16_bf16 v[120:135], v[140:143], v[160:163], v[120:135]
    s_waitcnt lgkmcnt(0)
    s_barrier
    v_mfma_f32_32x32x16_bf16 v[40:55], v[144:147], v[164:167], v[40:55]
    ds_read_b128 v[136:139], v19 offset:49152
    ds_read_b64_tr_b16 v[152:153], v21 offset:16384
    v_mfma_f32_32x32x16_bf16 v[56:71], v[144:147], v[168:171], v[56:71]
    ds_read_b64_tr_b16 v[154:155], v21 offset:16896
    ds_read_b64_tr_b16 v[156:157], v22 offset:16384
    v_mfma_f32_32x32x16_bf16 v[88:103], v[148:151], v[164:167], v[88:103]
    ds_read_b64_tr_b16 v[158:159], v22 offset:16896
    ds_read_b128 v[140:143], v19 offset:53248
    v_mfma_f32_32x32x16_bf16 v[104:119], v[148:151], v[168:171], v[104:119]
    ds_read_b64_tr_b16 v[160:161], v23 offset:16384
    ds_read_b64_tr_b16 v[162:163], v23 offset:16896
    v_mfma_f32_32x32x16_bf16 v[72:87], v[144:147], v[172:175], v[72:87]
    v_mfma_f32_32x32x16_bf16 v[120:135], v[148:151], v[172:175], v[120:135]
    s_waitcnt lgkmcnt(5)
    v_mfma_f32_32x32x16_bf16 v[40:55], v[136:139], v[152:155], v[40:55]
    ds_read_b128 v[144:147], v20 offset:49152
    ds_read_b64_tr_b16 v[164:165], v21 offset:18432
    s_waitcnt lgkmcnt(5)
    v_mfma_f32_32x32x16_bf16 v[56:71], v[136:139], v[156:159], v[56:71]
    ds_read_b64_tr_b16 v[166:167], v21 offset:18944
    ds_read_b64_tr_b16 v[168:169], v22 offset:18432
    s_waitcnt lgkmcnt(6)
    v_mfma_f32_32x32x16_bf16 v[88:103], v[140:143], v[152:155], v[88:103]
    ds_read_b64_tr_b16 v[170:171], v22 offset:18944
    ds_read_b128 v[148:151], v20 offset:53248
    v_mfma_f32_32x32x16_bf16 v[104:119], v[140:143], v[156:159], v[104:119]
    ds_read_b64_tr_b16 v[172:173], v23 offset:18432
    ds_read_b64_tr_b16 v[174:175], v23 offset:18944
    s_waitcnt lgkmcnt(8)
    v_mfma_f32_32x32x16_bf16 v[72:87], v[136:139], v[160:163], v[72:87]
    v_mfma_f32_32x32x16_bf16 v[120:135], v[140:143], v[160:163], v[120:135]
    s_waitcnt lgkmcnt(0)
    s_barrier
    v_mfma_f32_32x32x16_bf16 v[40:55], v[144:147], v[164:167], v[40:55]
    ds_read_b128 v[136:139], v17 offset:0
    ds_read_b64_tr_b16 v[152:153], v21 offset:32768
    v_mfma_f32_32x32x16_bf16 v[56:71], v[144:147], v[168:171], v[56:71]
    ds_read_b64_tr_b16 v[154:155], v21 offset:33280
    ds_read_b64_tr_b16 v[156:157], v22 offset:32768
    v_mfma_f32_32x32x16_bf16 v[88:103], v[148:151], v[164:167], v[88:103]
    ds_read_b64_tr_b16 v[158:159], v22 offset:33280
    ds_read_b128 v[140:143], v17 offset:4096
    v_mfma_f32_32x32x16_bf16 v[104:119], v[148:151], v[168:171], v[104:119]
    ds_read_b64_tr_b16 v[160:161], v23 offset:32768
    ds_read_b64_tr_b16 v[162:163], v23 offset:33280
    v_mfma_f32_32x32x16_bf16 v[72:87], v[144:147], v[172:175], v[72:87]
    v_mfma_f32_32x32x16_bf16 v[120:135], v[148:151], v[172:175], v[120:135]
    s_waitcnt lgkmcnt(5)
    v_mfma_f32_32x32x16_bf16 v[40:55], v[136:139], v[152:155], v[40:55]
    ds_read_b128 v[144:147], v18 offset:0
    ds_read_b64_tr_b16 v[164:165], v21 offset:34816
    s_waitcnt lgkmcnt(5)
    v_mfma_f32_32x32x16_bf16 v[56:71], v[136:139], v[156:159], v[56:71]
    ds_read_b64_tr_b16 v[166:167], v21 offset:35328
    ds_read_b64_tr_b16 v[168:169], v22 offset:34816
    s_waitcnt lgkmcnt(6)
    v_mfma_f32_32x32x16_bf16 v[88:103], v[140:143], v[152:155], v[88:103]
    ds_read_b64_tr_b16 v[170:171], v22 offset:35328
    ds_read_b128 v[148:151], v18 offset:4096
    v_mfma_f32_32x32x16_bf16 v[104:119], v[140:143], v[156:159], v[104:119]
    ds_read_b64_tr_b16 v[172:173], v23 offset:34816
    ds_read_b64_tr_b16 v[174:175], v23 offset:35328
    s_waitcnt lgkmcnt(8)
    v_mfma_f32_32x32x16_bf16 v[72:87], v[136:139], v[160:163], v[72:87]
    v_mfma_f32_32x32x16_bf16 v[120:135], v[140:143], v[160:163], v[120:135]
    v_mov_b32 v36, 0
    buffer_load_dword v36, v36, s[20:23], 0 offen sc1
    s_waitcnt lgkmcnt(0)
    s_barrier
    v_mfma_f32_32x32x16_bf16 v[40:55], v[144:147], v[164:167], v[40:55]
    ds_read_b128 v[136:139], v19 offset:0
    ds_read_b64_tr_b16 v[152:153], v21 offset:49152
    v_mfma_f32_32x32x16_bf16 v[56:71], v[144:147], v[168:171], v[56:71]
    ds_read_b64_tr_b16 v[154:155], v21 offset:49664
    ds_read_b64_tr_b16 v[156:157], v22 offset:49152
    v_mfma_f32_32x32x16_bf16 v[88:103], v[148:151], v[164:167], v[88:103]
    ds_read_b64_tr_b16 v[158:159], v22 offset:49664
    ds_read_b128 v[140:143], v19 offset:4096
    v_mfma_f32_32x32x16_bf16 v[104:119], v[148:151], v[168:171], v[104:119]
    ds_read_b64_tr_b16 v[160:161], v23 offset:49152
    ds_read_b64_tr_b16 v[162:163], v23 offset:49664
    v_mfma_f32_32x32x16_bf16 v[72:87], v[144:147], v[172:175], v[72:87]
    v_mfma_f32_32x32x16_bf16 v[120:135], v[148:151], v[172:175], v[120:135]
    s_waitcnt lgkmcnt(5)
    v_mfma_f32_32x32x16_bf16 v[40:55], v[136:139], v[152:155], v[40:55]
    ds_read_b128 v[144:147], v20 offset:0
    ds_read_b64_tr_b16 v[164:165], v21 offset:51200
    s_waitcnt lgkmcnt(5)
    v_mfma_f32_32x32x16_bf16 v[56:71], v[136:139], v[156:159], v[56:71]
    ds_read_b64_tr_b16 v[166:167], v21 offset:51712
    ds_read_b64_tr_b16 v[168:169], v22 offset:51200
    s_waitcnt lgkmcnt(6)
    v_mfma_f32_32x32x16_bf16 v[88:103], v[140:143], v[152:155], v[88:103]
    ds_read_b64_tr_b16 v[170:171], v22 offset:51712
    ds_read_b128 v[148:151], v20 offset:4096
    v_mfma_f32_32x32x16_bf16 v[104:119], v[140:143], v[156:159], v[104:119]
    ds_read_b64_tr_b16 v[172:173], v23 offset:51200
    ds_read_b64_tr_b16 v[174:175], v23 offset:51712
    s_waitcnt lgkmcnt(8)
    v_mfma_f32_32x32x16_bf16 v[72:87], v[136:139], v[160:163], v[72:87]
    v_mfma_f32_32x32x16_bf16 v[120:135], v[140:143], v[160:163], v[120:135]
    s_waitcnt lgkmcnt(0)
    s_barrier
    v_mfma_f32_32x32x16_bf16 v[40:55], v[144:147], v[164:167], v[40:55]
    ds_read_b128 v[136:139], v17 offset:16384
    ds_read_b64_tr_b16 v[152:153], v24 offset:0
    v_mfma_f32_32x32x16_bf16 v[56:71], v[144:147], v[168:171], v[56:71]
    ds_read_b64_tr_b16 v[154:155], v24 offset:512
    ds_read_b64_tr_b16 v[156:157], v25 offset:0
    v_mfma_f32_32x32x16_bf16 v[88:103], v[148:151], v[164:167], v[88:103]
    ds_read_b64_tr_b16 v[158:159], v25 offset:512
    ds_read_b128 v[140:143], v17 offset:20480
    v_mfma_f32_32x32x16_bf16 v[104:119], v[148:151], v[168:171], v[104:119]
    ds_read_b64_tr_b16 v[160:161], v26 offset:0
    ds_read_b64_tr_b16 v[162:163], v26 offset:512
    v_mfma_f32_32x32x16_bf16 v[72:87], v[144:147], v[172:175], v[72:87]
    v_mfma_f32_32x32x16_bf16 v[120:135], v[148:151], v[172:175], v[120:135]
    s_waitcnt lgkmcnt(5)
    v_mfma_f32_32x32x16_bf16 v[40:55], v[136:139], v[152:155], v[40:55]
    ds_read_b128 v[144:147], v18 offset:16384
    ds_read_b64_tr_b16 v[164:165], v24 offset:2048
    s_waitcnt lgkmcnt(5)
    v_mfma_f32_32x32x16_bf16 v[56:71], v[136:139], v[156:159], v[56:71]
    ds_read_b64_tr_b16 v[166:167], v24 offset:2560
    ds_read_b64_tr_b16 v[168:169], v25 offset:2048
    s_waitcnt lgkmcnt(6)
    v_mfma_f32_32x32x16_bf16 v[88:103], v[140:143], v[152:155], v[88:103]
    ds_read_b64_tr_b16 v[170:171], v25 offset:2560
    ds_read_b128 v[148:151], v18 offset:20480
    v_mfma_f32_32x32x16_bf16 v[104:119], v[140:143], v[156:159], v[104:119]
    ds_read_b64_tr_b16 v[172:173], v26 offset:2048
    ds_read_b64_tr_b16 v[174:175], v26 offset:2560
    s_waitcnt lgkmcnt(8)
    v_mfma_f32_32x32x16_bf16 v[72:87], v[136:139], v[160:163], v[72:87]
    v_mfma_f32_32x32x16_bf16 v[120:135], v[140:143], v[160:163], v[120:135]
    s_waitcnt lgkmcnt(0)
    s_barrier
    v_mfma_f32_32x32x16_bf16 v[40:55], v[144:147], v[164:167], v[40:55]
    ds_read_b128 v[136:139], v19 offset:16384
    ds_read_b64_tr_b16 v[152:153], v24 offset:16384
    v_mfma_f32_32x32x16_bf16 v[56:71], v[144:147], v[168:171], v[56:71]
    ds_read_b64_tr_b16 v[154:155], v24 offset:16896
    ds_read_b64_tr_b16 v[156:157], v25 offset:16384
    v_mfma_f32_32x32x16_bf16 v[88:103], v[148:151], v[164:167], v[88:103]
    ds_read_b64_tr_b16 v[158:159], v25 offset:16896
    ds_read_b128 v[140:143], v19 offset:20480
    v_mfma_f32_32x32x16_bf16 v[104:119], v[148:151], v[168:171], v[104:119]
    ds_read_b64_tr_b16 v[160:161], v26 offset:16384
    ds_read_b64_tr_b16 v[162:163], v26 offset:16896
    v_mfma_f32_32x32x16_bf16 v[72:87], v[144:147], v[172:175], v[72:87]
    v_mfma_f32_32x32x16_bf16 v[120:135], v[148:151], v[172:175], v[120:135]
    s_waitcnt lgkmcnt(5)
    v_mfma_f32_32x32x16_bf16 v[40:55], v[136:139], v[152:155], v[40:55]
    ds_read_b128 v[144:147], v20 offset:16384
    ds_read_b64_tr_b16 v[164:165], v24 offset:18432
    s_waitcnt lgkmcnt(5)
    v_mfma_f32_32x32x16_bf16 v[56:71], v[136:139], v[156:159], v[56:71]
    ds_read_b64_tr_b16 v[166:167], v24 offset:18944
    ds_read_b64_tr_b16 v[168:169], v25 offset:18432
    s_waitcnt lgkmcnt(6)
    v_mfma_f32_32x32x16_bf16 v[88:103], v[140:143], v[152:155], v[88:103]
    ds_read_b64_tr_b16 v[170:171], v25 offset:18944
    ds_read_b128 v[148:151], v20 offset:20480
    v_mfma_f32_32x32x16_bf16 v[104:119], v[140:143], v[156:159], v[104:119]
    ds_read_b64_tr_b16 v[172:173], v26 offset:18432
    ds_read_b64_tr_b16 v[174:175], v26 offset:18944
    s_waitcnt lgkmcnt(8)
    v_mfma_f32_32x32x16_bf16 v[72:87], v[136:139], v[160:163], v[72:87]
    v_mfma_f32_32x32x16_bf16 v[120:135], v[140:143], v[160:163], v[120:135]
    s_waitcnt lgkmcnt(0)
    s_barrier
    v_mfma_f32_32x32x16_bf16 v[40:55], v[144:147], v[164:167], v[40:55]
    ds_read_b128 v[192:195], v17 offset:32768
    ds_read_b128 v[196:199], v18 offset:32768
    v_mfma_f32_32x32x16_bf16 v[56:71], v[144:147], v[168:171], v[56:71]
    ds_read_b128 v[200:203], v19 offset:32768
    ds_read_b128 v[204:207], v20 offset:32768
    v_mfma_f32_32x32x16_bf16 v[88:103], v[148:151], v[164:167], v[88:103]
    ds_read_b64_tr_b16 v[208:209], v21 offset:0
    ds_read_b64_tr_b16 v[210:211], v21 offset:512
    v_mfma_f32_32x32x16_bf16 v[104:119], v[148:151], v[168:171], v[104:119]
    ds_read_b64_tr_b16 v[212:213], v21 offset:2048
    ds_read_b64_tr_b16 v[214:215], v21 offset:2560
    v_mfma_f32_32x32x16_bf16 v[72:87], v[144:147], v[172:175], v[72:87]
    ds_read_b64_tr_b16 v[216:217], v21 offset:16384
    ds_read_b64_tr_b16 v[218:219], v21 offset:16896
    v_mfma_f32_32x32x16_bf16 v[120:135], v[148:151], v[172:175], v[120:135]
    ds_read_b64_tr_b16 v[220:221], v21 offset:18432
    ds_read_b64_tr_b16 v[222:223], v21 offset:18944
    s_waitcnt lgkmcnt(0)
    ds_read_b128 v[136:139], v17 offset:36864
    ds_read_b128 v[140:143], v18 offset:36864
    v_mfma_f32_32x32x16_bf16 v[40:55], v[192:195], v[208:211], v[40:55]
    ds_read_b128 v[144:147], v19 offset:36864
    ds_read_b128 v[148:151], v20 offset:36864
    v_mfma_f32_32x32x16_bf16 v[40:55], v[196:199], v[212:215], v[40:55]
    v_mfma_f32_32x32x16_bf16 v[40:55], v[200:203], v[216:219], v[40:55]
    v_mfma_f32_32x32x16_bf16 v[40:55], v[204:207], v[220:223], v[40:55]
    s_waitcnt lgkmcnt(0)
    ds_read_b64_tr_b16 v[152:153], v22 offset:0
    ds_read_b64_tr_b16 v[154:155], v22 offset:512
    v_mfma_f32_32x32x16_bf16 v[88:103], v[136:139], v[208:211], v[88:103]
    ds_read_b64_tr_b16 v[156:157], v22 offset:2048
    ds_read_b64_tr_b16 v[158:159], v22 offset:2560
    v_mfma_f32_32x32x16_bf16 v[88:103], v[140:143], v[212:215], v[88:103]
    s_nop 4
    v_cvt_pk_bf16_f32 v176, v40, v41
    v_cvt_pk_bf16_f32 v177, v42, v43
    v_cvt_pk_bf16_f32 v178, v44, v45
    v_cvt_pk_bf16_f32 v179, v46, v47
    v_cvt_pk_bf16_f32 v180, v48, v49
    v_cvt_pk_bf16_f32 v181, v50, v51
    v_cvt_pk_bf16_f32 v182, v52, v53
    ds_read_b64_tr_b16 v[160:161], v22 offset:16384
    ds_read_b64_tr_b16 v[162:163], v22 offset:16896
    v_mfma_f32_32x32x16_bf16 v[88:103], v[144:147], v[216:219], v[88:103]
    v_cvt_pk_bf16_f32 v183, v54, v55
    s_mov_b32 exec_lo, 0xf0000000
    s_mov_b32 exec_hi, 0xf0000000
    v_mov_b32 v176, v35
    v_mov_b32 v177, v35
    v_mov_b32 v178, v35
    v_mov_b32 v179, v35
    v_mov_b32 v180, v35
    v_mov_b32 v181, v35
    v_mov_b32 v182, v35
    v_mov_b32 v183, v35
    s_mov_b64 exec, -1
    buffer_store_dwordx4 v[176:179], v27, s[8:11], s66 offen offset:0 sc1
    buffer_store_dwordx4 v[180:183], v27, s[8:11], s66 offen offset:1024 sc1
    ds_read_b64_tr_b16 v[164:165], v22 offset:18432
    ds_read_b64_tr_b16 v[166:167], v22 offset:18944
    v_mfma_f32_32x32x16_bf16 v[88:103], v[148:151], v[220:223], v[88:103]
    s_waitcnt lgkmcnt(0)
    ds_read_b64_tr_b16 v[168:169], v23 offset:0
    ds_read_b64_tr_b16 v[170:171], v23 offset:512
    v_mfma_f32_32x32x16_bf16 v[56:71], v[192:195], v[152:155], v[56:71]
    ds_read_b64_tr_b16 v[172:173], v23 offset:2048
    ds_read_b64_tr_b16 v[174:175], v23 offset:2560
    v_mfma_f32_32x32x16_bf16 v[56:71], v[196:199], v[156:159], v[56:71]
    s_nop 4
    v_cvt_pk_bf16_f32 v184, v88, v89
    v_cvt_pk_bf16_f32 v185, v90, v91
    v_cvt_pk_bf16_f32 v186, v92, v93
    v_cvt_pk_bf16_f32 v187, v94, v95
    v_cvt_pk_bf16_f32 v188, v96, v97
    v_cvt_pk_bf16_f32 v189, v98, v99
    v_cvt_pk_bf16_f32 v190, v100, v101
    ds_read_b64_tr_b16 v[224:225], v23 offset:16384
    ds_read_b64_tr_b16 v[226:227], v23 offset:16896
    v_mfma_f32_32x32x16_bf16 v[56:71], v[200:203], v[160:163], v[56:71]
    v_cvt_pk_bf16_f32 v191, v102, v103
    s_mov_b32 exec_lo, 0xf0000000
    s_mov_b32 exec_hi, 0xf0000000
    v_mov_b32 v184, v35
    v_mov_b32 v185, v35
    v_mov_b32 v186, v35
    v_mov_b32 v187, v35
    v_mov_b32 v188, v35
    v_mov_b32 v189, v35
    v_mov_b32 v190, v35
    v_mov_b32 v191, v35
    s_mov_b64 exec, -1
    buffer_store_dwordx4 v[184:187], v27, s[8:11], s66 offen offset:2048 sc1
    buffer_store_dwordx4 v[188:191], v27, s[8:11], s66 offen offset:3072 sc1
    ds_read_b64_tr_b16 v[228:229], v23 offset:18432
    ds_read_b64_tr_b16 v[230:231], v23 offset:18944
    v_mfma_f32_32x32x16_bf16 v[56:71], v[204:207], v[164:167], v[56:71]
    s_waitcnt lgkmcnt(0)
    v_mfma_f32_32x32x16_bf16 v[104:119], v[136:139], v[152:155], v[104:119]
    v_mfma_f32_32x32x16_bf16 v[104:119], v[140:143], v[156:159], v[104:119]
    s_nop 8
    v_cvt_pk_bf16_f32 v176, v56, v57
    v_cvt_pk_bf16_f32 v177, v58, v59
    v_cvt_pk_bf16_f32 v178, v60, v61
    v_cvt_pk_bf16_f32 v179, v62, v63
    v_cvt_pk_bf16_f32 v180, v64, v65
    v_cvt_pk_bf16_f32 v181, v66, v67
    v_cvt_pk_bf16_f32 v182, v68, v69
    v_mfma_f32_32x32x16_bf16 v[104:119], v[144:147], v[160:163], v[104:119]
    v_cvt_pk_bf16_f32 v183, v70, v71
    s_mov_b32 exec_lo, 0xf0000000
    s_mov_b32 exec_hi, 0xf0000000
    v_mov_b32 v176, v35
    v_mov_b32 v177, v35
    v_mov_b32 v178, v35
    v_mov_b32 v179, v35
    v_mov_b32 v180, v35
    v_mov_b32 v181, v35
    v_mov_b32 v182, v35
    v_mov_b32 v183, v35
    s_mov_b64 exec, -1
    buffer_store_dwordx4 v[176:179], v27, s[8:11], s67 offen offset:0 sc1
    buffer_store_dwordx4 v[180:183], v27, s[8:11], s67 offen offset:1024 sc1
    v_mfma_f32_32x32x16_bf16 v[104:119], v[148:151], v[164:167], v[104:119]
    s_waitcnt lgkmcnt(0)
    v_mfma_f32_32x32x16_bf16 v[72:87], v[192:195], v[168:171], v[72:87]
    v_mfma_f32_32x32x16_bf16 v[72:87], v[196:199], v[172:175], v[72:87]
    s_nop 8
    v_cvt_pk_bf16_f32 v184, v104, v105
    v_cvt_pk_bf16_f32 v185, v106, v107
    v_cvt_pk_bf16_f32 v186, v108, v109
    v_cvt_pk_bf16_f32 v187, v110, v111
    v_cvt_pk_bf16_f32 v188, v112, v113
    v_cvt_pk_bf16_f32 v189, v114, v115
    v_cvt_pk_bf16_f32 v190, v116, v117
    v_mfma_f32_32x32x16_bf16 v[72:87], v[200:203], v[224:227], v[72:87]
    v_cvt_pk_bf16_f32 v191, v118, v119
    s_mov_b32 exec_lo, 0xf0000000
    s_mov_b32 exec_hi, 0xf0000000
    v_mov_b32 v184, v35
    v_mov_b32 v185, v35
    v_mov_b32 v186, v35
    v_mov_b32 v187, v35
    v_mov_b32 v188, v35
    v_mov_b32 v189, v35
    v_mov_b32 v190, v35
    v_mov_b32 v191, v35
    s_mov_b64 exec, -1
    buffer_store_dwordx4 v[184:187], v27, s[8:11], s67 offen offset:2048 sc1
    buffer_store_dwordx4 v[188:191], v27, s[8:11], s67 offen offset:3072 sc1
    v_mfma_f32_32x32x16_bf16 v[72:87], v[204:207], v[228:231], v[72:87]
    s_waitcnt lgkmcnt(0)
    v_mfma_f32_32x32x16_bf16 v[120:135], v[136:139], v[168:171], v[120:135]
    v_mfma_f32_32x32x16_bf16 v[120:135], v[140:143], v[172:175], v[120:135]
    s_nop 8
    v_cvt_pk_bf16_f32 v176, v72, v73
    v_cvt_pk_bf16_f32 v177, v74, v75
    v_cvt_pk_bf16_f32 v178, v76, v77
    v_cvt_pk_bf16_f32 v179, v78, v79
    v_cvt_pk_bf16_f32 v180, v80, v81
    v_cvt_pk_bf16_f32 v181, v82, v83
    v_cvt_pk_bf16_f32 v182, v84, v85
    v_mfma_f32_32x32x16_bf16 v[120:135], v[144:147], v[224:227], v[120:135]
    v_cvt_pk_bf16_f32 v183, v86, v87
    s_mov_b32 exec_lo, 0xf0000000
    s_mov_b32 exec_hi, 0xf0000000
    v_mov_b32 v176, v35
    v_mov_b32 v177, v35
    v_mov_b32 v178, v35
    v_mov_b32 v179, v35
    v_mov_b32 v180, v35
    v_mov_b32 v181, v35
    v_mov_b32 v182, v35
    v_mov_b32 v183, v35
    s_mov_b64 exec, -1
    buffer_store_dwordx4 v[176:179], v27, s[8:11], s33 offen offset:0 sc1
    buffer_store_dwordx4 v[180:183], v27, s[8:11], s33 offen offset:1024 sc1
    v_mfma_f32_32x32x16_bf16 v[120:135], v[148:151], v[228:231], v[120:135]
    s_nop 11
    v_cvt_pk_bf16_f32 v184, v120, v121
    v_cvt_pk_bf16_f32 v185, v122, v123
    v_cvt_pk_bf16_f32 v186, v124, v125
    v_cvt_pk_bf16_f32 v187, v126, v127
    v_cvt_pk_bf16_f32 v188, v128, v129
    v_cvt_pk_bf16_f32 v189, v130, v131
    v_cvt_pk_bf16_f32 v190, v132, v133
    v_cvt_pk_bf16_f32 v191, v134, v135
    s_mov_b32 exec_lo, 0xf0000000
    s_mov_b32 exec_hi, 0xf0000000
    v_mov_b32 v184, v35
    v_mov_b32 v185, v35
    v_mov_b32 v186, v35
    v_mov_b32 v187, v35
    v_mov_b32 v188, v35
    v_mov_b32 v189, v35
    v_mov_b32 v190, v35
    v_mov_b32 v191, v35
    s_mov_b64 exec, -1
    buffer_store_dwordx4 v[184:187], v27, s[8:11], s33 offen offset:2048 sc1
    buffer_store_dwordx4 v[188:191], v27, s[8:11], s33 offen offset:3072 sc1
    s_waitcnt vmcnt(0)
    s_branch concat_heads__linear_kernel_hedgehog__mha_block__prompt_kernel_p1_end
concat_heads__linear_kernel_hedgehog__mha_block__prompt_kernel_p1_end:
    s_barrier
    s_cmp_lt_u32 s26, 4
    s_cbranch_scc1 concat_heads__linear_kernel_hedgehog__mha_block__prompt_kernel_p1_cw
    s_waitcnt vmcnt(0)
    v_add_u32 v16, 151552, v16
    ds_write_b64 v16, v[14:15]
    v_mov_b32 v2, 0
    v_mov_b32 v1, 153600
    ds_write_b32 v1, v2
    ds_write_b32 v1, v2 offset:4
    ds_write_b32 v1, v2 offset:8
    s_branch concat_heads__linear_kernel_hedgehog__mha_block__prompt_kernel_s1_wait
concat_heads__linear_kernel_hedgehog__mha_block__prompt_kernel_p1_cw:
    s_cmp_eq_u32 s26, 0
    s_cbranch_scc0 concat_heads__linear_kernel_hedgehog__mha_block__prompt_kernel_s1_wait
    v_readfirstlane_b32 s30, v36
    s_nop 0
    s_cmp_ge_u32 s30, 32
    s_nop 1
    s_cbranch_scc1 concat_heads__linear_kernel_hedgehog__mha_block__prompt_kernel_zc_ok
    v_mov_b32 v1, 0
    v_mov_b32 v2, 32
    s_mov_b32 s36, 0
    s_nop 0
concat_heads__linear_kernel_hedgehog__mha_block__prompt_kernel_zcp:
    buffer_load_dword v3, v1, s[20:23], 0 offen sc1
    s_add_u32 s36, s36, 1
    s_waitcnt vmcnt(0)
    v_cmp_ge_u32 vcc, v3, v2
    s_nop 0
    s_cmp_eq_u64 vcc, exec
    s_nop 1
    s_cbranch_scc1 concat_heads__linear_kernel_hedgehog__mha_block__prompt_kernel_zcp_ok
    s_cmp_ge_u32 s36, 400000
    s_cbranch_scc1 concat_heads__linear_kernel_hedgehog__mha_block__prompt_kernel_zcp_ok
    s_sleep 2
    s_branch concat_heads__linear_kernel_hedgehog__mha_block__prompt_kernel_zcp
concat_heads__linear_kernel_hedgehog__mha_block__prompt_kernel_zcp_ok:
concat_heads__linear_kernel_hedgehog__mha_block__prompt_kernel_zc_ok:
    s_lshl_b32 s30, s27, 3
    s_add_u32 s30, s30, s29
    s_lshl_b32 s30, s30, 4
    s_add_u32 s30, s30, s28
    s_lshl_b32 s30, s30, 7
    s_add_u32 s30, s30, 19398656
    v_mov_b32 v1, 0
    v_mov_b32 v2, 1
    s_mov_b64 exec, 1
    buffer_store_dword v2, v1, s[8:11], s30 offen sc1
    s_mov_b64 exec, -1
concat_heads__linear_kernel_hedgehog__mha_block__prompt_kernel_s1_wait:
    s_cmp_lt_u32 s26, 4
    s_cbranch_scc1 concat_heads__linear_kernel_hedgehog__mha_block__prompt_kernel_wo_skip
    s_sub_u32 s60, s26, 4
    s_cmp_eq_u32 s27, 0
    s_cselect_b32 s4, s46, s52
    s_cselect_b32 s5, s47, s53
    s_mov_b32 s16, s4
    s_mov_b32 s17, s5
    s_mov_b32 s18, 401408
    s_mov_b32 s19, 0x00020000
    v_lshrrev_b32 v1, 3, v0
    v_mul_u32_u24 v1, 896, v1
    v_bfe_u32 v2, v0, 4, 1
    v_lshlrev_b32 v2, 2, v2
    v_and_b32 v3, 7, v0
    v_xor_b32 v2, v2, v3
    v_lshl_add_u32 v1, v2, 4, v1
    s_mul_i32 s30, s60, 7168
    s_lshl_b32 s31, s29, 7
    s_add_u32 s30, s30, s31
    s_cmp_lt_u32 s25, 28
    s_cselect_b32 s30, s30, 0x40000000
    s_lshl_b32 s31, s60, 10
    s_add_u32 m0, s31, 81920
    s_add_u32 s32, s30, 0
    buffer_load_dwordx4 v1, s[16:19], s32 offen lds
    s_add_u32 m0, s31, 86016
    s_add_u32 s32, s30, 28672
    buffer_load_dwordx4 v1, s[16:19], s32 offen lds
    s_add_u32 m0, s31, 90112
    s_add_u32 s32, s30, 57344
    buffer_load_dwordx4 v1, s[16:19], s32 offen lds
    s_add_u32 m0, s31, 94208
    s_add_u32 s32, s30, 86016
    buffer_load_dwordx4 v1, s[16:19], s32 offen lds
    s_add_u32 m0, s31, 98304
    s_add_u32 s32, s30, 114688
    buffer_load_dwordx4 v1, s[16:19], s32 offen lds
    s_add_u32 m0, s31, 102400
    s_add_u32 s32, s30, 143360
    buffer_load_dwordx4 v1, s[16:19], s32 offen lds
    s_add_u32 m0, s31, 106496
    s_add_u32 s32, s30, 172032
    buffer_load_dwordx4 v1, s[16:19], s32 offen lds
    s_add_u32 m0, s31, 110592
    s_add_u32 s32, s30, 200704
    buffer_load_dwordx4 v1, s[16:19], s32 offen lds
    s_add_u32 m0, s31, 114688
    s_add_u32 s32, s30, 229376
    buffer_load_dwordx4 v1, s[16:19], s32 offen lds
    s_add_u32 m0, s31, 118784
    s_add_u32 s32, s30, 258048
    buffer_load_dwordx4 v1, s[16:19], s32 offen lds
    s_add_u32 m0, s31, 122880
    s_add_u32 s32, s30, 286720
    buffer_load_dwordx4 v1, s[16:19], s32 offen lds
    s_add_u32 m0, s31, 126976
    s_add_u32 s32, s30, 315392
    buffer_load_dwordx4 v1, s[16:19], s32 offen lds
    s_add_u32 m0, s31, 131072
    s_add_u32 s32, s30, 344064
    buffer_load_dwordx4 v1, s[16:19], s32 offen lds
    s_add_u32 m0, s31, 135168
    s_add_u32 s32, s30, 372736
    buffer_load_dwordx4 v1, s[16:19], s32 offen lds
    s_add_u32 m0, s31, 139264
    s_add_u32 s32, s30, 401408
    buffer_load_dwordx4 v1, s[16:19], s32 offen lds
concat_heads__linear_kernel_hedgehog__mha_block__prompt_kernel_wo_skip:
    s_lshl_b32 s30, s24, 1
    s_and_b32 s31, s25, 1
    s_add_u32 s37, s30, s31
    s_lshr_b32 s38, s25, 1
    v_lshlrev_b32 v1, 4, v0
    s_mov_b32 s34, 0
    s_mov_b32 s35, -1
    s_mov_b32 s66, 0
    s_mov_b32 s0, 0x3fb8aa3b
    s_mov_b32 s1, 0x3fb8aa3b
    s_and_b32 s60, s26, 1
    s_lshr_b32 s61, s26, 1
    s_lshl_b32 s39, s37, 17
    s_lshl_b32 s30, s38, 2
    s_lshl_b32 s31, s60, 1
    s_add_u32 s30, s30, s31
    s_lshl_b32 s30, s30, 11
    s_add_u32 s64, s30, s39
    s_add_u32 s64, s64, 6291456
    s_add_u32 s30, s39, 8388608
    s_mov_b32 s31, s61
    s_lshl_b32 s31, s31, 15
    s_add_u32 s67, s30, s31
    s_cmp_eq_u32 s26, 0
    s_cbranch_scc0 concat_heads__linear_kernel_hedgehog__mha_block__prompt_kernel_s1_ok
    s_mul_i32 s30, s37, 43
    s_lshr_b32 s30, s30, 8
    s_add_u32 s31, s37, 16
    s_mul_i32 s31, s31, 43
    s_lshr_b32 s31, s31, 8
    s_add_u32 s32, s37, 32
    s_mul_i32 s32, s32, 43
    s_lshr_b32 s32, s32, 8
    v_and_b32 v2, 15, v0
    v_lshrrev_b32 v3, 4, v0
    v_mov_b32 v4, s30
    v_mov_b32 v5, s31
    v_cmp_eq_u32 vcc, 1, v3
    s_nop 1
    v_cndmask_b32 v4, v4, v5, vcc
    v_mov_b32 v5, s32
    v_cmp_eq_u32 vcc, 2, v3
    s_nop 1
    v_cndmask_b32 v4, v4, v5, vcc
    v_add_u32 v4, 8, v4
    v_mov_b32 v5, s38
    v_cmp_eq_u32 vcc, 0, v3
    s_nop 1
    v_cndmask_b32 v2, v2, v5, vcc
    v_lshl_add_u32 v2, v4, 4, v2
    v_mov_b32 v4, s30
    v_mov_b32 v6, s31
    v_cmp_eq_u32 vcc, 49, v0
    s_nop 1
    v_cndmask_b32 v4, v4, v6, vcc
    v_mov_b32 v6, s32
    v_cmp_lt_u32 vcc, 49, v0
    s_nop 1
    v_cndmask_b32 v4, v4, v6, vcc
    v_lshl_add_u32 v4, v4, 4, v5
    v_cmp_lt_u32 vcc, 47, v0
    s_nop 1
    v_cndmask_b32 v2, v2, v4, vcc
    v_lshlrev_b32 v2, 7, v2
    v_add_u32 v2, 19398656, v2
    v_mov_b32 v3, 1
    s_mov_b32 s36, 0
    s_nop 0
concat_heads__linear_kernel_hedgehog__mha_block__prompt_kernel_s1p:
    buffer_load_dword v4, v2, s[8:11], 0 offen sc1
    s_add_u32 s36, s36, 1
    s_waitcnt vmcnt(0)
    v_cmp_ge_u32 vcc, v4, v3
    s_nop 0
    s_cmp_eq_u64 vcc, exec
    s_nop 1
    s_cbranch_scc1 concat_heads__linear_kernel_hedgehog__mha_block__prompt_kernel_s1p_ok
    s_cmp_ge_u32 s36, 400000
    s_cbranch_scc1 concat_heads__linear_kernel_hedgehog__mha_block__prompt_kernel_s1p_ok
    s_sleep 1
    s_branch concat_heads__linear_kernel_hedgehog__mha_block__prompt_kernel_s1p
concat_heads__linear_kernel_hedgehog__mha_block__prompt_kernel_s1p_ok:
concat_heads__linear_kernel_hedgehog__mha_block__prompt_kernel_s1_ok:
    s_waitcnt lgkmcnt(0)
    s_barrier
    s_cmp_lt_u32 s26, 4
    s_cbranch_scc1 concat_heads__linear_kernel_hedgehog__mha_block__prompt_kernel_pro_early
    buffer_load_dwordx4 v[12:15], v1, s[8:11], s64 offen offset:0
    buffer_load_dwordx4 v[16:19], v1, s[8:11], s64 offen offset:1024
    buffer_load_dwordx4 v[20:23], v1, s[8:11], s64 offen offset:2048
    buffer_load_dwordx4 v[24:27], v1, s[8:11], s64 offen offset:3072
    s_add_u32 s30, s39, 8388608
    buffer_load_dwordx4 v[52:55], v1, s[8:11], s30 offen
    buffer_load_dwordx4 v[56:59], v1, s[8:11], s30 offen offset:1024
    s_add_u32 s62, s67, 0
    s_add_u32 s63, s67, 2097152
    buffer_load_dwordx4 v[28:31], v1, s[8:11], s62 offen offset:0
    buffer_load_dwordx4 v[32:35], v1, s[8:11], s62 offen offset:1024
    buffer_load_dwordx4 v[60:63], v1, s[8:11], s63 offen offset:0
    buffer_load_dwordx4 v[64:67], v1, s[8:11], s63 offen offset:1024
    v_lshlrev_b32 v2, 7, v0
    s_lshl_b32 s30, s38, 13
    s_add_u32 s30, s30, s39
    s_mov_b32 s31, 0x40000000
    s_cmp_eq_u32 s26, 5
    s_cselect_b32 s31, 8388608, s31
    s_cmp_eq_u32 s26, 6
    s_cselect_b32 s31, 10485760, s31
    s_cmp_eq_u32 s26, 7
    s_cselect_b32 s31, 0, s31
    s_add_u32 s30, s30, s31
    buffer_load_dword v7, v2, s[8:11], s30 offen
    s_branch concat_heads__linear_kernel_hedgehog__mha_block__prompt_kernel_att_m
concat_heads__linear_kernel_hedgehog__mha_block__prompt_kernel_pro_early:
    s_lshl_b32 s31, s38, 2
    s_add_u32 s30, s26, s31
    s_lshl_b32 s30, s30, 11
    s_add_u32 s30, s30, s39
    s_add_u32 s30, s30, 2097152
    buffer_load_dwordx4 v[164:167], v1, s[8:11], s30 offen
    buffer_load_dwordx4 v[168:171], v1, s[8:11], s30 offen offset:1024
    s_cmp_lt_u32 s26, 2
    s_cbranch_scc0 concat_heads__linear_kernel_hedgehog__mha_block__prompt_kernel_pro_e2
    s_lshl_b32 s30, s38, 13
    s_add_u32 s30, s30, s39
    s_add_u32 s30, s30, 4194304
    s_add_u32 s31, s30, 4096
    buffer_load_dwordx4 v[92:95], v1, s[8:11], s30 offen offset:0
    buffer_load_dwordx4 v[96:99], v1, s[8:11], s30 offen offset:1024
    buffer_load_dwordx4 v[100:103], v1, s[8:11], s30 offen offset:2048
    buffer_load_dwordx4 v[104:107], v1, s[8:11], s30 offen offset:3072
    buffer_load_dwordx4 v[108:111], v1, s[8:11], s31 offen offset:0
    buffer_load_dwordx4 v[112:115], v1, s[8:11], s31 offen offset:1024
    buffer_load_dwordx4 v[116:119], v1, s[8:11], s31 offen offset:2048
    buffer_load_dwordx4 v[120:123], v1, s[8:11], s31 offen offset:3072
concat_heads__linear_kernel_hedgehog__mha_block__prompt_kernel_pro_e2:
    s_setprio 2
    v_lshrrev_b32 v2, 5, v0
    v_lshlrev_b32 v2, 2, v2
    v_bfe_u32 v3, v0, 2, 2
    v_add_u32 v2, v2, v3
    v_mul_u32_u24 v2, 56, v2
    v_bfe_u32 v3, v0, 4, 1
    v_lshl_add_u32 v2, v3, 5, v2
    v_and_b32 v4, 3, v0
    v_lshl_add_u32 v2, v4, 3, v2
    v_add_u32 v2, 151552, v2
    ds_read_b64_tr_b16 v[172:173], v2 offset:0
    ds_read_b64_tr_b16 v[174:175], v2 offset:448
    ds_read_b64_tr_b16 v[176:177], v2 offset:896
    ds_read_b64_tr_b16 v[178:179], v2 offset:1344
    s_waitcnt vmcnt(8) lgkmcnt(0)
    s_cmp_lt_u32 s26, 2
    s_cbranch_scc1 concat_heads__linear_kernel_hedgehog__mha_block__prompt_kernel_kf_ok
    s_waitcnt vmcnt(0)
concat_heads__linear_kernel_hedgehog__mha_block__prompt_kernel_kf_ok:
    buffer_load_dwordx4 v[12:15], v1, s[8:11], s64 offen offset:0
    buffer_load_dwordx4 v[16:19], v1, s[8:11], s64 offen offset:1024
    buffer_load_dwordx4 v[20:23], v1, s[8:11], s64 offen offset:2048
    buffer_load_dwordx4 v[24:27], v1, s[8:11], s64 offen offset:3072
    s_add_u32 s30, s39, 8388608
    buffer_load_dwordx4 v[52:55], v1, s[8:11], s30 offen
    buffer_load_dwordx4 v[56:59], v1, s[8:11], s30 offen offset:1024
    s_add_u32 s62, s67, 0
    s_add_u32 s63, s67, 2097152
    buffer_load_dwordx4 v[28:31], v1, s[8:11], s62 offen offset:0
    buffer_load_dwordx4 v[32:35], v1, s[8:11], s62 offen offset:1024
    buffer_load_dwordx4 v[60:63], v1, s[8:11], s63 offen offset:0
    buffer_load_dwordx4 v[64:67], v1, s[8:11], s63 offen offset:1024
    v_mfma_f32_32x32x16_bf16 v[124:139], v[172:175], v[164:167], 0
    v_mfma_f32_32x32x16_bf16 v[124:139], v[176:179], v[168:171], v[124:139]
    s_mov_b64 exec, s[34:35]
    s_nop 10
    v_mov_b32 v136, v132
    v_mov_b32 v137, v133
    v_mov_b32 v138, v134
    v_mov_b32 v139, v135
    s_mov_b64 exec, -1
    v_max3_f32 v2, v124, v125, v126
    v_min3_f32 v3, v124, v125, v126
    v_max3_f32 v2, v2, v127, v128
    v_min3_f32 v3, v3, v127, v128
    v_max3_f32 v2, v2, v129, v130
    v_min3_f32 v3, v3, v129, v130
    v_max3_f32 v2, v2, v131, v132
    v_min3_f32 v3, v3, v131, v132
    v_max3_f32 v2, v2, v133, v134
    v_min3_f32 v3, v3, v133, v134
    v_max3_f32 v2, v2, v135, v136
    v_min3_f32 v3, v3, v135, v136
    v_max3_f32 v2, v2, v137, v138
    v_min3_f32 v3, v3, v137, v138
    v_max_f32 v2, v2, v139
    v_min_f32 v3, v3, v139
    v_mov_b32 v4, v2
    v_mov_b32 v5, v2
    s_nop 1
    v_permlane32_swap_b32 v4, v5
    v_max_f32 v2, v4, v5
    v_mov_b32 v4, v3
    v_mov_b32 v5, v3
    s_nop 1
    v_permlane32_swap_b32 v4, v5
    v_min_f32 v3, v4, v5
    v_mul_f32 v2, s0, v2
    v_mul_f32 v3, s0, v3
    v_mov_b32 v4, v2
    v_mov_b32 v5, v2
    v_pk_fma_f32 v[140:141], v[124:125], s[0:1], v[4:5] neg_lo:[0,0,1] neg_hi:[0,0,1]
    v_pk_fma_f32 v[142:143], v[126:127], s[0:1], v[4:5] neg_lo:[0,0,1] neg_hi:[0,0,1]
    v_pk_fma_f32 v[144:145], v[128:129], s[0:1], v[4:5] neg_lo:[0,0,1] neg_hi:[0,0,1]
    v_pk_fma_f32 v[146:147], v[130:131], s[0:1], v[4:5] neg_lo:[0,0,1] neg_hi:[0,0,1]
    v_pk_fma_f32 v[148:149], v[132:133], s[0:1], v[4:5] neg_lo:[0,0,1] neg_hi:[0,0,1]
    v_pk_fma_f32 v[150:151], v[134:135], s[0:1], v[4:5] neg_lo:[0,0,1] neg_hi:[0,0,1]
    v_pk_fma_f32 v[152:153], v[136:137], s[0:1], v[4:5] neg_lo:[0,0,1] neg_hi:[0,0,1]
    v_pk_fma_f32 v[154:155], v[138:139], s[0:1], v[4:5] neg_lo:[0,0,1] neg_hi:[0,0,1]
    v_exp_f32 v140, v140
    v_exp_f32 v141, v141
    v_exp_f32 v142, v142
    v_exp_f32 v143, v143
    v_exp_f32 v144, v144
    v_exp_f32 v145, v145
    v_exp_f32 v146, v146
    v_exp_f32 v147, v147
    v_exp_f32 v148, v148
    v_exp_f32 v149, v149
    v_exp_f32 v150, v150
    v_exp_f32 v151, v151
    v_exp_f32 v152, v152
    v_exp_f32 v153, v153
    v_exp_f32 v154, v154
    v_exp_f32 v155, v155
    s_mov_b64 exec, s[34:35]
    v_mov_b32 v152, 0
    v_mov_b32 v153, 0
    v_mov_b32 v154, 0
    v_mov_b32 v155, 0
    s_mov_b64 exec, -1
    v_pk_add_f32 v[180:181], v[140:141], v[142:143]
    v_pk_add_f32 v[180:181], v[180:181], v[144:145]
    v_pk_add_f32 v[180:181], v[180:181], v[146:147]
    v_pk_add_f32 v[180:181], v[180:181], v[148:149]
    v_pk_add_f32 v[180:181], v[180:181], v[150:151]
    v_pk_add_f32 v[180:181], v[180:181], v[152:153]
    v_pk_add_f32 v[180:181], v[180:181], v[154:155]
    v_add_f32 v6, v180, v181
    v_mov_b32 v4, v6
    v_mov_b32 v5, v6
    s_nop 1
    v_permlane32_swap_b32 v4, v5
    v_add_f32 v6, v4, v5
    v_rcp_f32 v6, v6
    s_nop 0
    v_mov_b32 v4, v6
    v_mov_b32 v5, v6
    v_pk_mul_f32 v[140:141], v[140:141], v[4:5]
    v_pk_mul_f32 v[142:143], v[142:143], v[4:5]
    v_pk_mul_f32 v[144:145], v[144:145], v[4:5]
    v_pk_mul_f32 v[146:147], v[146:147], v[4:5]
    v_pk_mul_f32 v[148:149], v[148:149], v[4:5]
    v_pk_mul_f32 v[150:151], v[150:151], v[4:5]
    v_pk_mul_f32 v[152:153], v[152:153], v[4:5]
    v_pk_mul_f32 v[154:155], v[154:155], v[4:5]
    v_cvt_pk_bf16_f32 v180, v140, v141
    v_cvt_pk_bf16_f32 v181, v142, v143
    v_cvt_pk_bf16_f32 v182, v144, v145
    v_cvt_pk_bf16_f32 v183, v146, v147
    v_cvt_pk_bf16_f32 v184, v148, v149
    v_cvt_pk_bf16_f32 v185, v150, v151
    v_cvt_pk_bf16_f32 v186, v152, v153
    v_cvt_pk_bf16_f32 v187, v154, v155
    v_mov_b32 v4, v3
    v_mov_b32 v5, v3
    v_pk_fma_f32 v[140:141], v[124:125], s[0:1], v[4:5] neg_lo:[1,0,0] neg_hi:[1,0,0]
    v_pk_fma_f32 v[142:143], v[126:127], s[0:1], v[4:5] neg_lo:[1,0,0] neg_hi:[1,0,0]
    v_pk_fma_f32 v[144:145], v[128:129], s[0:1], v[4:5] neg_lo:[1,0,0] neg_hi:[1,0,0]
    v_pk_fma_f32 v[146:147], v[130:131], s[0:1], v[4:5] neg_lo:[1,0,0] neg_hi:[1,0,0]
    v_pk_fma_f32 v[148:149], v[132:133], s[0:1], v[4:5] neg_lo:[1,0,0] neg_hi:[1,0,0]
    v_pk_fma_f32 v[150:151], v[134:135], s[0:1], v[4:5] neg_lo:[1,0,0] neg_hi:[1,0,0]
    v_pk_fma_f32 v[152:153], v[136:137], s[0:1], v[4:5] neg_lo:[1,0,0] neg_hi:[1,0,0]
    v_pk_fma_f32 v[154:155], v[138:139], s[0:1], v[4:5] neg_lo:[1,0,0] neg_hi:[1,0,0]
    v_exp_f32 v140, v140
    v_exp_f32 v141, v141
    v_exp_f32 v142, v142
    v_exp_f32 v143, v143
    v_exp_f32 v144, v144
    v_exp_f32 v145, v145
    v_exp_f32 v146, v146
    v_exp_f32 v147, v147
    v_exp_f32 v148, v148
    v_exp_f32 v149, v149
    v_exp_f32 v150, v150
    v_exp_f32 v151, v151
    v_exp_f32 v152, v152
    v_exp_f32 v153, v153
    v_exp_f32 v154, v154
    v_exp_f32 v155, v155
    s_mov_b64 exec, s[34:35]
    v_mov_b32 v152, 0
    v_mov_b32 v153, 0
    v_mov_b32 v154, 0
    v_mov_b32 v155, 0
    s_mov_b64 exec, -1
    v_pk_add_f32 v[188:189], v[140:141], v[142:143]
    v_pk_add_f32 v[188:189], v[188:189], v[144:145]
    v_pk_add_f32 v[188:189], v[188:189], v[146:147]
    v_pk_add_f32 v[188:189], v[188:189], v[148:149]
    v_pk_add_f32 v[188:189], v[188:189], v[150:151]
    v_pk_add_f32 v[188:189], v[188:189], v[152:153]
    v_pk_add_f32 v[188:189], v[188:189], v[154:155]
    v_add_f32 v6, v188, v189
    v_mov_b32 v4, v6
    v_mov_b32 v5, v6
    s_nop 1
    v_permlane32_swap_b32 v4, v5
    v_add_f32 v6, v4, v5
    v_rcp_f32 v6, v6
    s_nop 0
    v_mov_b32 v4, v6
    v_mov_b32 v5, v6
    v_pk_mul_f32 v[140:141], v[140:141], v[4:5]
    v_pk_mul_f32 v[142:143], v[142:143], v[4:5]
    v_pk_mul_f32 v[144:145], v[144:145], v[4:5]
    v_pk_mul_f32 v[146:147], v[146:147], v[4:5]
    v_pk_mul_f32 v[148:149], v[148:149], v[4:5]
    v_pk_mul_f32 v[150:151], v[150:151], v[4:5]
    v_pk_mul_f32 v[152:153], v[152:153], v[4:5]
    v_pk_mul_f32 v[154:155], v[154:155], v[4:5]
    v_cvt_pk_bf16_f32 v188, v140, v141
    v_cvt_pk_bf16_f32 v189, v142, v143
    v_cvt_pk_bf16_f32 v190, v144, v145
    v_cvt_pk_bf16_f32 v191, v146, v147
    v_cvt_pk_bf16_f32 v192, v148, v149
    v_cvt_pk_bf16_f32 v193, v150, v151
    v_cvt_pk_bf16_f32 v194, v152, v153
    v_cvt_pk_bf16_f32 v195, v154, v155
    s_mul_i32 s30, s26, 2304
    v_and_b32 v2, 31, v0
    v_mul_u32_u24 v2, 72, v2
    v_lshrrev_b32 v3, 5, v0
    v_lshlrev_b32 v3, 3, v3
    v_add3_u32 v2, v2, v3, s30
    ds_write_b64 v2, v[180:181] offset:0
    ds_write_b64 v2, v[182:183] offset:16
    ds_write_b64 v2, v[184:185] offset:32
    ds_write_b64 v2, v[186:187] offset:48
    ds_write_b64 v2, v[188:189] offset:9216
    ds_write_b64 v2, v[190:191] offset:9232
    ds_write_b64 v2, v[192:193] offset:9248
    ds_write_b64 v2, v[194:195] offset:9264
    s_waitcnt lgkmcnt(0)
    v_mov_b32 v3, 153600
    v_mov_b32 v4, 1
    s_mov_b64 exec, 1
    ds_add_u32 v3, v4
    s_mov_b64 exec, -1
    s_cmp_lt_u32 s26, 2
    s_cbranch_scc0 concat_heads__linear_kernel_hedgehog__mha_block__prompt_kernel_kv_done
    s_mov_b32 s36, 0
concat_heads__linear_kernel_hedgehog__mha_block__prompt_kernel_phi_wait:
    ds_read_b32 v4, v3
    s_add_u32 s36, s36, 1
    s_waitcnt lgkmcnt(0)
    v_readfirstlane_b32 s30, v4
    s_nop 0
    s_cmp_ge_u32 s30, 4
    s_nop 1
    s_cbranch_scc1 concat_heads__linear_kernel_hedgehog__mha_block__prompt_kernel_phi_ok
    s_cmp_ge_u32 s36, 400000
    s_cbranch_scc1 concat_heads__linear_kernel_hedgehog__mha_block__prompt_kernel_phi_ok
    s_branch concat_heads__linear_kernel_hedgehog__mha_block__prompt_kernel_phi_wait
concat_heads__linear_kernel_hedgehog__mha_block__prompt_kernel_phi_ok:
    s_mul_i32 s30, s26, 9216
    v_lshrrev_b32 v2, 5, v0
    v_lshlrev_b32 v2, 2, v2
    v_bfe_u32 v3, v0, 2, 2
    v_add_u32 v2, v2, v3
    v_mul_u32_u24 v2, 72, v2
    v_bfe_u32 v3, v0, 4, 1
    v_lshl_add_u32 v2, v3, 5, v2
    v_and_b32 v4, 3, v0
    v_lshl_add_u32 v2, v4, 3, v2
    v_add_u32 v2, s30, v2
    ds_read_b64_tr_b16 v[180:181], v2 offset:0
    ds_read_b64_tr_b16 v[182:183], v2 offset:576
    ds_read_b64_tr_b16 v[184:185], v2 offset:1152
    ds_read_b64_tr_b16 v[186:187], v2 offset:1728
    ds_read_b64_tr_b16 v[188:189], v2 offset:2304
    ds_read_b64_tr_b16 v[190:191], v2 offset:2880
    ds_read_b64_tr_b16 v[192:193], v2 offset:3456
    ds_read_b64_tr_b16 v[194:195], v2 offset:4032
    s_waitcnt lgkmcnt(0)
    ds_read_b64_tr_b16 v[196:197], v2 offset:4608
    ds_read_b64_tr_b16 v[198:199], v2 offset:5184
    ds_read_b64_tr_b16 v[200:201], v2 offset:5760
    ds_read_b64_tr_b16 v[202:203], v2 offset:6336
    ds_read_b64_tr_b16 v[204:205], v2 offset:6912
    ds_read_b64_tr_b16 v[206:207], v2 offset:7488
    ds_read_b64_tr_b16 v[208:209], v2 offset:8064
    ds_read_b64_tr_b16 v[210:211], v2 offset:8640
    s_waitcnt vmcnt(0) lgkmcnt(0)
    v_mfma_f32_32x32x16_bf16 v[124:139], v[180:183], v[92:95], 0
    v_mfma_f32_32x32x16_bf16 v[124:139], v[184:187], v[96:99], v[124:139]
    v_mfma_f32_32x32x16_bf16 v[124:139], v[188:191], v[100:103], v[124:139]
    v_mfma_f32_32x32x16_bf16 v[124:139], v[192:195], v[104:107], v[124:139]
    v_mfma_f32_32x32x16_bf16 v[124:139], v[196:199], v[108:111], v[124:139]
    v_mfma_f32_32x32x16_bf16 v[124:139], v[200:203], v[112:115], v[124:139]
    v_mfma_f32_32x32x16_bf16 v[124:139], v[204:207], v[116:119], v[124:139]
    v_mfma_f32_32x32x16_bf16 v[124:139], v[208:211], v[120:123], v[124:139]
    s_lshl_b32 s30, s37, 4
    s_add_u32 s30, s30, s38
    s_lshl_b32 s30, s30, 1
    s_add_u32 s30, s30, s26
    s_lshl_b32 s30, s30, 12
    s_add_u32 s30, s30, 16777216
    s_nop 5
    buffer_store_dwordx4 v[124:127], v1, s[8:11], s30 offen offset:0 sc1
    buffer_store_dwordx4 v[128:131], v1, s[8:11], s30 offen offset:1024 sc1
    buffer_store_dwordx4 v[132:135], v1, s[8:11], s30 offen offset:2048 sc1
    buffer_store_dwordx4 v[136:139], v1, s[8:11], s30 offen offset:3072 sc1
    s_waitcnt vmcnt(0)
    v_mov_b32 v3, 153600
    v_mov_b32 v4, 1
    s_mov_b64 exec, 1
    ds_add_rtn_u32 v5, v3, v4 offset:8
    s_waitcnt lgkmcnt(0)
    v_readfirstlane_b32 s30, v5
    s_mov_b64 exec, -1
    s_cmp_eq_u32 s30, 1
    s_nop 1
    s_cbranch_scc0 concat_heads__linear_kernel_hedgehog__mha_block__prompt_kernel_kv_done
    s_lshl_b32 s4, s37, 4
    s_add_u32 s4, s4, s38
    s_lshl_b32 s4, s4, 7
    s_add_u32 s4, s4, 19464192
    v_mov_b32 v2, 0
    v_mov_b32 v3, 1
    s_mov_b64 exec, 1
    buffer_store_dword v3, v2, s[8:11], s4 offen sc1
    s_mov_b64 exec, -1
    s_branch concat_heads__linear_kernel_hedgehog__mha_block__prompt_kernel_kv_done1
concat_heads__linear_kernel_hedgehog__mha_block__prompt_kernel_kv_done:
    s_waitcnt vmcnt(0)
concat_heads__linear_kernel_hedgehog__mha_block__prompt_kernel_kv_done1:
    s_waitcnt lgkmcnt(0)
concat_heads__linear_kernel_hedgehog__mha_block__prompt_kernel_att_m:
    s_waitcnt vmcnt(5)
    s_mov_b64 exec, s[34:35]
    v_mov_b32 v18, 0
    v_mov_b32 v19, 0
    v_mov_b32 v26, 0
    v_mov_b32 v27, 0
    s_mov_b64 exec, -1
    v_mfma_f32_32x32x16_bf16 v[124:139], v[52:55], v[12:15], 0
    v_mfma_f32_32x32x16_bf16 v[124:139], v[56:59], v[16:19], v[124:139]
    v_mfma_f32_32x32x16_bf16 v[140:155], v[52:55], v[20:23], 0
    v_mfma_f32_32x32x16_bf16 v[140:155], v[56:59], v[24:27], v[140:155]
    buffer_load_dwordx4 v[36:39], v1, s[8:11], s62 offen offset:2048
    buffer_load_dwordx4 v[40:43], v1, s[8:11], s62 offen offset:3072
    buffer_load_dwordx4 v[68:71], v1, s[8:11], s63 offen offset:2048
    buffer_load_dwordx4 v[72:75], v1, s[8:11], s63 offen offset:3072
    s_add_u32 s62, s67, 4096
    s_add_u32 s63, s67, 2101248
    buffer_load_dwordx4 v[44:47], v1, s[8:11], s62 offen offset:0
    buffer_load_dwordx4 v[48:51], v1, s[8:11], s62 offen offset:1024
    buffer_load_dwordx4 v[76:79], v1, s[8:11], s63 offen offset:0
    buffer_load_dwordx4 v[80:83], v1, s[8:11], s63 offen offset:1024
    v_max3_f32 v156, v124, v125, v126
    v_max3_f32 v156, v156, v127, v128
    v_max3_f32 v156, v156, v129, v130
    v_max3_f32 v156, v156, v131, v132
    v_max3_f32 v156, v156, v133, v134
    v_max3_f32 v156, v156, v135, v136
    v_max3_f32 v156, v156, v137, v138
    v_max_f32 v156, v156, v139
    v_max3_f32 v157, v140, v141, v142
    v_max3_f32 v157, v157, v143, v144
    v_max3_f32 v157, v157, v145, v146
    v_max3_f32 v157, v157, v147, v148
    v_max3_f32 v157, v157, v149, v150
    v_max3_f32 v157, v157, v151, v152
    v_max3_f32 v157, v157, v153, v154
    v_max_f32 v157, v157, v155
    v_mov_b32 v4, v156
    v_mov_b32 v5, v156
    s_nop 1
    v_permlane32_swap_b32 v4, v5
    v_max_f32 v156, v4, v5
    v_add_f32 v156, 0x42b40000, v156
    v_and_b32 v156, 0xffff0000, v156
    v_xor_b32 v2, 0x80000000, v156
    v_lshrrev_b32 v2, 16, v2
    s_mov_b64 exec, s[34:35]
    v_mov_b32 v18, v2
    s_mov_b64 exec, -1
    v_mov_b32 v4, v157
    v_mov_b32 v5, v157
    s_nop 1
    v_permlane32_swap_b32 v4, v5
    v_max_f32 v157, v4, v5
    v_add_f32 v157, 0x42b40000, v157
    v_and_b32 v157, 0xffff0000, v157
    v_xor_b32 v2, 0x80000000, v157
    v_lshrrev_b32 v2, 16, v2
    s_mov_b64 exec, s[34:35]
    v_mov_b32 v26, v2
    s_mov_b64 exec, -1
    s_nop 0
concat_heads__linear_kernel_hedgehog__mha_block__prompt_kernel_att_go:
    s_waitcnt vmcnt(11)
    v_mfma_f32_32x32x16_bf16 v[124:139], v[28:31], v[12:15], 0
    v_mfma_f32_32x32x16_bf16 v[124:139], v[32:35], v[16:19], v[124:139]
    s_nop 11
    v_exp_f32 v124, v124
    v_exp_f32 v125, v125
    v_exp_f32 v126, v126
    v_exp_f32 v127, v127
    v_cvt_pk_bf16_f32 v156, v124, v125
    v_cvt_pk_bf16_f32 v157, v126, v127
    v_exp_f32 v128, v128
    v_exp_f32 v129, v129
    v_mfma_f32_32x32x16_bf16 v[140:155], v[28:31], v[20:23], 0
    buffer_load_dwordx4 v[52:55], v1, s[8:11], s62 offen offset:2048
    buffer_load_dwordx4 v[56:59], v1, s[8:11], s62 offen offset:3072
    v_exp_f32 v130, v130
    v_exp_f32 v131, v131
    v_cvt_pk_bf16_f32 v158, v128, v129
    v_cvt_pk_bf16_f32 v159, v130, v131
    v_mfma_f32_32x32x16_bf16 v[140:155], v[32:35], v[24:27], v[140:155]
    v_exp_f32 v132, v132
    v_exp_f32 v133, v133
    buffer_load_dwordx4 v[84:87], v1, s[8:11], s63 offen offset:2048
    buffer_load_dwordx4 v[88:91], v1, s[8:11], s63 offen offset:3072
    v_exp_f32 v134, v134
    v_exp_f32 v135, v135
    v_cvt_pk_bf16_f32 v160, v132, v133
    v_cvt_pk_bf16_f32 v161, v134, v135
    v_exp_f32 v136, v136
    v_exp_f32 v137, v137
    s_waitcnt vmcnt(13)
    v_mfma_f32_32x32x16_bf16 v[92:107], v[60:63], v[156:159], 0
    v_exp_f32 v138, v138
    v_exp_f32 v139, v139
    v_cvt_pk_bf16_f32 v162, v136, v137
    v_cvt_pk_bf16_f32 v163, v138, v139
    v_exp_f32 v140, v140
    v_exp_f32 v141, v141
    v_mfma_f32_32x32x16_bf16 v[92:107], v[64:67], v[160:163], v[92:107]
    v_exp_f32 v142, v142
    v_exp_f32 v143, v143
    v_cvt_pk_bf16_f32 v156, v140, v141
    v_cvt_pk_bf16_f32 v157, v142, v143
    v_exp_f32 v144, v144
    v_exp_f32 v145, v145
    s_waitcnt vmcnt(10)
    v_mfma_f32_32x32x16_bf16 v[124:139], v[36:39], v[12:15], 0
    v_exp_f32 v146, v146
    v_exp_f32 v147, v147
    v_cvt_pk_bf16_f32 v158, v144, v145
    v_cvt_pk_bf16_f32 v159, v146, v147
    v_mfma_f32_32x32x16_bf16 v[124:139], v[40:43], v[16:19], v[124:139]
    v_exp_f32 v148, v148
    v_exp_f32 v149, v149
    v_exp_f32 v150, v150
    v_exp_f32 v151, v151
    v_cvt_pk_bf16_f32 v160, v148, v149
    v_cvt_pk_bf16_f32 v161, v150, v151
    v_exp_f32 v152, v152
    v_exp_f32 v153, v153
    v_mfma_f32_32x32x16_bf16 v[108:123], v[60:63], v[156:159], 0
    v_exp_f32 v154, v154
    v_exp_f32 v155, v155
    v_cvt_pk_bf16_f32 v162, v152, v153
    v_cvt_pk_bf16_f32 v163, v154, v155
    v_exp_f32 v124, v124
    v_exp_f32 v125, v125
    v_mfma_f32_32x32x16_bf16 v[108:123], v[64:67], v[160:163], v[108:123]
    v_exp_f32 v126, v126
    v_exp_f32 v127, v127
    v_cvt_pk_bf16_f32 v156, v124, v125
    v_cvt_pk_bf16_f32 v157, v126, v127
    v_exp_f32 v128, v128
    v_exp_f32 v129, v129
    v_mfma_f32_32x32x16_bf16 v[140:155], v[36:39], v[20:23], 0
    s_add_u32 s62, s67, 8192
    s_add_u32 s63, s67, 2105344
    buffer_load_dwordx4 v[28:31], v1, s[8:11], s62 offen offset:0
    buffer_load_dwordx4 v[32:35], v1, s[8:11], s62 offen offset:1024
    v_exp_f32 v130, v130
    v_exp_f32 v131, v131
    v_cvt_pk_bf16_f32 v158, v128, v129
    v_cvt_pk_bf16_f32 v159, v130, v131
    v_mfma_f32_32x32x16_bf16 v[140:155], v[40:43], v[24:27], v[140:155]
    v_exp_f32 v132, v132
    v_exp_f32 v133, v133
    buffer_load_dwordx4 v[60:63], v1, s[8:11], s63 offen offset:0
    buffer_load_dwordx4 v[64:67], v1, s[8:11], s63 offen offset:1024
    v_exp_f32 v134, v134
    v_exp_f32 v135, v135
    v_cvt_pk_bf16_f32 v160, v132, v133
    v_cvt_pk_bf16_f32 v161, v134, v135
    v_exp_f32 v136, v136
    v_exp_f32 v137, v137
    s_waitcnt vmcnt(12)
    v_mfma_f32_32x32x16_bf16 v[92:107], v[68:71], v[156:159], v[92:107]
    v_exp_f32 v138, v138
    v_exp_f32 v139, v139
    v_cvt_pk_bf16_f32 v162, v136, v137
    v_cvt_pk_bf16_f32 v163, v138, v139
    v_exp_f32 v140, v140
    v_exp_f32 v141, v141
    v_mfma_f32_32x32x16_bf16 v[92:107], v[72:75], v[160:163], v[92:107]
    v_exp_f32 v142, v142
    v_exp_f32 v143, v143
    v_cvt_pk_bf16_f32 v156, v140, v141
    v_cvt_pk_bf16_f32 v157, v142, v143
    v_exp_f32 v144, v144
    v_exp_f32 v145, v145
    s_waitcnt vmcnt(10)
    v_mfma_f32_32x32x16_bf16 v[124:139], v[44:47], v[12:15], 0
    v_exp_f32 v146, v146
    v_exp_f32 v147, v147
    v_cvt_pk_bf16_f32 v158, v144, v145
    v_cvt_pk_bf16_f32 v159, v146, v147
    v_mfma_f32_32x32x16_bf16 v[124:139], v[48:51], v[16:19], v[124:139]
    v_exp_f32 v148, v148
    v_exp_f32 v149, v149
    v_exp_f32 v150, v150
    v_exp_f32 v151, v151
    v_cvt_pk_bf16_f32 v160, v148, v149
    v_cvt_pk_bf16_f32 v161, v150, v151
    v_exp_f32 v152, v152
    v_exp_f32 v153, v153
    v_mfma_f32_32x32x16_bf16 v[108:123], v[68:71], v[156:159], v[108:123]
    v_exp_f32 v154, v154
    v_exp_f32 v155, v155
    v_cvt_pk_bf16_f32 v162, v152, v153
    v_cvt_pk_bf16_f32 v163, v154, v155
    v_exp_f32 v124, v124
    v_exp_f32 v125, v125
    v_mfma_f32_32x32x16_bf16 v[108:123], v[72:75], v[160:163], v[108:123]
    v_exp_f32 v126, v126
    v_exp_f32 v127, v127
    v_cvt_pk_bf16_f32 v156, v124, v125
    v_cvt_pk_bf16_f32 v157, v126, v127
    v_exp_f32 v128, v128
    v_exp_f32 v129, v129
    v_mfma_f32_32x32x16_bf16 v[140:155], v[44:47], v[20:23], 0
    buffer_load_dwordx4 v[36:39], v1, s[8:11], s62 offen offset:2048
    buffer_load_dwordx4 v[40:43], v1, s[8:11], s62 offen offset:3072
    v_exp_f32 v130, v130
    v_exp_f32 v131, v131
    v_cvt_pk_bf16_f32 v158, v128, v129
    v_cvt_pk_bf16_f32 v159, v130, v131
    v_mfma_f32_32x32x16_bf16 v[140:155], v[48:51], v[24:27], v[140:155]
    v_exp_f32 v132, v132
    v_exp_f32 v133, v133
    buffer_load_dwordx4 v[68:71], v1, s[8:11], s63 offen offset:2048
    buffer_load_dwordx4 v[72:75], v1, s[8:11], s63 offen offset:3072
    v_exp_f32 v134, v134
    v_exp_f32 v135, v135
    v_cvt_pk_bf16_f32 v160, v132, v133
    v_cvt_pk_bf16_f32 v161, v134, v135
    v_exp_f32 v136, v136
    v_exp_f32 v137, v137
    s_waitcnt vmcnt(12)
    v_mfma_f32_32x32x16_bf16 v[92:107], v[76:79], v[156:159], v[92:107]
    v_exp_f32 v138, v138
    v_exp_f32 v139, v139
    v_cvt_pk_bf16_f32 v162, v136, v137
    v_cvt_pk_bf16_f32 v163, v138, v139
    v_exp_f32 v140, v140
    v_exp_f32 v141, v141
    v_mfma_f32_32x32x16_bf16 v[92:107], v[80:83], v[160:163], v[92:107]
    v_exp_f32 v142, v142
    v_exp_f32 v143, v143
    v_cvt_pk_bf16_f32 v156, v140, v141
    v_cvt_pk_bf16_f32 v157, v142, v143
    v_exp_f32 v144, v144
    v_exp_f32 v145, v145
    s_waitcnt vmcnt(10)
    v_mfma_f32_32x32x16_bf16 v[124:139], v[52:55], v[12:15], 0
    v_exp_f32 v146, v146
    v_exp_f32 v147, v147
    v_cvt_pk_bf16_f32 v158, v144, v145
    v_cvt_pk_bf16_f32 v159, v146, v147
    v_mfma_f32_32x32x16_bf16 v[124:139], v[56:59], v[16:19], v[124:139]
    v_exp_f32 v148, v148
    v_exp_f32 v149, v149
    v_exp_f32 v150, v150
    v_exp_f32 v151, v151
    v_cvt_pk_bf16_f32 v160, v148, v149
    v_cvt_pk_bf16_f32 v161, v150, v151
    v_exp_f32 v152, v152
    v_exp_f32 v153, v153
    v_mfma_f32_32x32x16_bf16 v[108:123], v[76:79], v[156:159], v[108:123]
    v_exp_f32 v154, v154
    v_exp_f32 v155, v155
    v_cvt_pk_bf16_f32 v162, v152, v153
    v_cvt_pk_bf16_f32 v163, v154, v155
    v_exp_f32 v124, v124
    v_exp_f32 v125, v125
    v_mfma_f32_32x32x16_bf16 v[108:123], v[80:83], v[160:163], v[108:123]
    v_exp_f32 v126, v126
    v_exp_f32 v127, v127
    v_cvt_pk_bf16_f32 v156, v124, v125
    v_cvt_pk_bf16_f32 v157, v126, v127
    v_exp_f32 v128, v128
    v_exp_f32 v129, v129
    v_mfma_f32_32x32x16_bf16 v[140:155], v[52:55], v[20:23], 0
    s_add_u32 s62, s67, 12288
    s_add_u32 s63, s67, 2109440
    buffer_load_dwordx4 v[44:47], v1, s[8:11], s62 offen offset:0
    buffer_load_dwordx4 v[48:51], v1, s[8:11], s62 offen offset:1024
    v_exp_f32 v130, v130
    v_exp_f32 v131, v131
    v_cvt_pk_bf16_f32 v158, v128, v129
    v_cvt_pk_bf16_f32 v159, v130, v131
    v_mfma_f32_32x32x16_bf16 v[140:155], v[56:59], v[24:27], v[140:155]
    v_exp_f32 v132, v132
    v_exp_f32 v133, v133
    buffer_load_dwordx4 v[76:79], v1, s[8:11], s63 offen offset:0
    buffer_load_dwordx4 v[80:83], v1, s[8:11], s63 offen offset:1024
    v_exp_f32 v134, v134
    v_exp_f32 v135, v135
    v_cvt_pk_bf16_f32 v160, v132, v133
    v_cvt_pk_bf16_f32 v161, v134, v135
    v_exp_f32 v136, v136
    v_exp_f32 v137, v137
    s_waitcnt vmcnt(12)
    v_mfma_f32_32x32x16_bf16 v[92:107], v[84:87], v[156:159], v[92:107]
    v_exp_f32 v138, v138
    v_exp_f32 v139, v139
    v_cvt_pk_bf16_f32 v162, v136, v137
    v_cvt_pk_bf16_f32 v163, v138, v139
    v_exp_f32 v140, v140
    v_exp_f32 v141, v141
    v_mfma_f32_32x32x16_bf16 v[92:107], v[88:91], v[160:163], v[92:107]
    v_exp_f32 v142, v142
    v_exp_f32 v143, v143
    v_cvt_pk_bf16_f32 v156, v140, v141
    v_cvt_pk_bf16_f32 v157, v142, v143
    v_exp_f32 v144, v144
    v_exp_f32 v145, v145
    s_waitcnt vmcnt(10)
    v_mfma_f32_32x32x16_bf16 v[124:139], v[28:31], v[12:15], 0
    v_exp_f32 v146, v146
    v_exp_f32 v147, v147
    v_cvt_pk_bf16_f32 v158, v144, v145
    v_cvt_pk_bf16_f32 v159, v146, v147
    v_mfma_f32_32x32x16_bf16 v[124:139], v[32:35], v[16:19], v[124:139]
    v_exp_f32 v148, v148
    v_exp_f32 v149, v149
    v_exp_f32 v150, v150
    v_exp_f32 v151, v151
    v_cvt_pk_bf16_f32 v160, v148, v149
    v_cvt_pk_bf16_f32 v161, v150, v151
    v_exp_f32 v152, v152
    v_exp_f32 v153, v153
    v_mfma_f32_32x32x16_bf16 v[108:123], v[84:87], v[156:159], v[108:123]
    v_exp_f32 v154, v154
    v_exp_f32 v155, v155
    v_cvt_pk_bf16_f32 v162, v152, v153
    v_cvt_pk_bf16_f32 v163, v154, v155
    v_exp_f32 v124, v124
    v_exp_f32 v125, v125
    v_mfma_f32_32x32x16_bf16 v[108:123], v[88:91], v[160:163], v[108:123]
    v_exp_f32 v126, v126
    v_exp_f32 v127, v127
    v_cvt_pk_bf16_f32 v156, v124, v125
    v_cvt_pk_bf16_f32 v157, v126, v127
    v_exp_f32 v128, v128
    v_exp_f32 v129, v129
    v_mfma_f32_32x32x16_bf16 v[140:155], v[28:31], v[20:23], 0
    buffer_load_dwordx4 v[52:55], v1, s[8:11], s62 offen offset:2048
    buffer_load_dwordx4 v[56:59], v1, s[8:11], s62 offen offset:3072
    v_exp_f32 v130, v130
    v_exp_f32 v131, v131
    v_cvt_pk_bf16_f32 v158, v128, v129
    v_cvt_pk_bf16_f32 v159, v130, v131
    v_mfma_f32_32x32x16_bf16 v[140:155], v[32:35], v[24:27], v[140:155]
    v_exp_f32 v132, v132
    v_exp_f32 v133, v133
    buffer_load_dwordx4 v[84:87], v1, s[8:11], s63 offen offset:2048
    buffer_load_dwordx4 v[88:91], v1, s[8:11], s63 offen offset:3072
    v_exp_f32 v134, v134
    v_exp_f32 v135, v135
    v_cvt_pk_bf16_f32 v160, v132, v133
    v_cvt_pk_bf16_f32 v161, v134, v135
    v_exp_f32 v136, v136
    v_exp_f32 v137, v137
    s_waitcnt vmcnt(12)
    v_mfma_f32_32x32x16_bf16 v[92:107], v[60:63], v[156:159], v[92:107]
    v_exp_f32 v138, v138
    v_exp_f32 v139, v139
    v_cvt_pk_bf16_f32 v162, v136, v137
    v_cvt_pk_bf16_f32 v163, v138, v139
    v_exp_f32 v140, v140
    v_exp_f32 v141, v141
    v_mfma_f32_32x32x16_bf16 v[92:107], v[64:67], v[160:163], v[92:107]
    v_exp_f32 v142, v142
    v_exp_f32 v143, v143
    v_cvt_pk_bf16_f32 v156, v140, v141
    v_cvt_pk_bf16_f32 v157, v142, v143
    v_exp_f32 v144, v144
    v_exp_f32 v145, v145
    s_waitcnt vmcnt(10)
    v_mfma_f32_32x32x16_bf16 v[124:139], v[36:39], v[12:15], 0
    v_exp_f32 v146, v146
    v_exp_f32 v147, v147
    v_cvt_pk_bf16_f32 v158, v144, v145
    v_cvt_pk_bf16_f32 v159, v146, v147
    v_mfma_f32_32x32x16_bf16 v[124:139], v[40:43], v[16:19], v[124:139]
    v_exp_f32 v148, v148
    v_exp_f32 v149, v149
    v_exp_f32 v150, v150
    v_exp_f32 v151, v151
    v_cvt_pk_bf16_f32 v160, v148, v149
    v_cvt_pk_bf16_f32 v161, v150, v151
    v_exp_f32 v152, v152
    v_exp_f32 v153, v153
    v_mfma_f32_32x32x16_bf16 v[108:123], v[60:63], v[156:159], v[108:123]
    v_exp_f32 v154, v154
    v_exp_f32 v155, v155
    v_cvt_pk_bf16_f32 v162, v152, v153
    v_cvt_pk_bf16_f32 v163, v154, v155
    v_exp_f32 v124, v124
    v_exp_f32 v125, v125
    v_mfma_f32_32x32x16_bf16 v[108:123], v[64:67], v[160:163], v[108:123]
    v_exp_f32 v126, v126
    v_exp_f32 v127, v127
    v_cvt_pk_bf16_f32 v156, v124, v125
    v_cvt_pk_bf16_f32 v157, v126, v127
    v_exp_f32 v128, v128
    v_exp_f32 v129, v129
    v_mfma_f32_32x32x16_bf16 v[140:155], v[36:39], v[20:23], 0
    s_add_u32 s62, s67, 16384
    s_add_u32 s63, s67, 2113536
    buffer_load_dwordx4 v[28:31], v1, s[8:11], s62 offen offset:0
    buffer_load_dwordx4 v[32:35], v1, s[8:11], s62 offen offset:1024
    v_exp_f32 v130, v130
    v_exp_f32 v131, v131
    v_cvt_pk_bf16_f32 v158, v128, v129
    v_cvt_pk_bf16_f32 v159, v130, v131
    v_mfma_f32_32x32x16_bf16 v[140:155], v[40:43], v[24:27], v[140:155]
    v_exp_f32 v132, v132
    v_exp_f32 v133, v133
    buffer_load_dwordx4 v[60:63], v1, s[8:11], s63 offen offset:0
    buffer_load_dwordx4 v[64:67], v1, s[8:11], s63 offen offset:1024
    v_exp_f32 v134, v134
    v_exp_f32 v135, v135
    v_cvt_pk_bf16_f32 v160, v132, v133
    v_cvt_pk_bf16_f32 v161, v134, v135
    v_exp_f32 v136, v136
    v_exp_f32 v137, v137
    s_waitcnt vmcnt(12)
    v_mfma_f32_32x32x16_bf16 v[92:107], v[68:71], v[156:159], v[92:107]
    v_exp_f32 v138, v138
    v_exp_f32 v139, v139
    v_cvt_pk_bf16_f32 v162, v136, v137
    v_cvt_pk_bf16_f32 v163, v138, v139
    v_exp_f32 v140, v140
    v_exp_f32 v141, v141
    v_mfma_f32_32x32x16_bf16 v[92:107], v[72:75], v[160:163], v[92:107]
    v_exp_f32 v142, v142
    v_exp_f32 v143, v143
    v_cvt_pk_bf16_f32 v156, v140, v141
    v_cvt_pk_bf16_f32 v157, v142, v143
    v_exp_f32 v144, v144
    v_exp_f32 v145, v145
    s_waitcnt vmcnt(10)
    v_mfma_f32_32x32x16_bf16 v[124:139], v[44:47], v[12:15], 0
    v_exp_f32 v146, v146
    v_exp_f32 v147, v147
    v_cvt_pk_bf16_f32 v158, v144, v145
    v_cvt_pk_bf16_f32 v159, v146, v147
    v_mfma_f32_32x32x16_bf16 v[124:139], v[48:51], v[16:19], v[124:139]
    v_exp_f32 v148, v148
    v_exp_f32 v149, v149
    v_exp_f32 v150, v150
    v_exp_f32 v151, v151
    v_cvt_pk_bf16_f32 v160, v148, v149
    v_cvt_pk_bf16_f32 v161, v150, v151
    v_exp_f32 v152, v152
    v_exp_f32 v153, v153
    v_mfma_f32_32x32x16_bf16 v[108:123], v[68:71], v[156:159], v[108:123]
    v_exp_f32 v154, v154
    v_exp_f32 v155, v155
    v_cvt_pk_bf16_f32 v162, v152, v153
    v_cvt_pk_bf16_f32 v163, v154, v155
    v_exp_f32 v124, v124
    v_exp_f32 v125, v125
    v_mfma_f32_32x32x16_bf16 v[108:123], v[72:75], v[160:163], v[108:123]
    v_exp_f32 v126, v126
    v_exp_f32 v127, v127
    v_cvt_pk_bf16_f32 v156, v124, v125
    v_cvt_pk_bf16_f32 v157, v126, v127
    v_exp_f32 v128, v128
    v_exp_f32 v129, v129
    v_mfma_f32_32x32x16_bf16 v[140:155], v[44:47], v[20:23], 0
    buffer_load_dwordx4 v[36:39], v1, s[8:11], s62 offen offset:2048
    buffer_load_dwordx4 v[40:43], v1, s[8:11], s62 offen offset:3072
    v_exp_f32 v130, v130
    v_exp_f32 v131, v131
    v_cvt_pk_bf16_f32 v158, v128, v129
    v_cvt_pk_bf16_f32 v159, v130, v131
    v_mfma_f32_32x32x16_bf16 v[140:155], v[48:51], v[24:27], v[140:155]
    v_exp_f32 v132, v132
    v_exp_f32 v133, v133
    buffer_load_dwordx4 v[68:71], v1, s[8:11], s63 offen offset:2048
    buffer_load_dwordx4 v[72:75], v1, s[8:11], s63 offen offset:3072
    v_exp_f32 v134, v134
    v_exp_f32 v135, v135
    v_cvt_pk_bf16_f32 v160, v132, v133
    v_cvt_pk_bf16_f32 v161, v134, v135
    v_exp_f32 v136, v136
    v_exp_f32 v137, v137
    s_waitcnt vmcnt(12)
    v_mfma_f32_32x32x16_bf16 v[92:107], v[76:79], v[156:159], v[92:107]
    v_exp_f32 v138, v138
    v_exp_f32 v139, v139
    v_cvt_pk_bf16_f32 v162, v136, v137
    v_cvt_pk_bf16_f32 v163, v138, v139
    v_exp_f32 v140, v140
    v_exp_f32 v141, v141
    v_mfma_f32_32x32x16_bf16 v[92:107], v[80:83], v[160:163], v[92:107]
    v_exp_f32 v142, v142
    v_exp_f32 v143, v143
    v_cvt_pk_bf16_f32 v156, v140, v141
    v_cvt_pk_bf16_f32 v157, v142, v143
    v_exp_f32 v144, v144
    v_exp_f32 v145, v145
    s_waitcnt vmcnt(10)
    v_mfma_f32_32x32x16_bf16 v[124:139], v[52:55], v[12:15], 0
    v_exp_f32 v146, v146
    v_exp_f32 v147, v147
    v_cvt_pk_bf16_f32 v158, v144, v145
    v_cvt_pk_bf16_f32 v159, v146, v147
    v_mfma_f32_32x32x16_bf16 v[124:139], v[56:59], v[16:19], v[124:139]
    v_exp_f32 v148, v148
    v_exp_f32 v149, v149
    v_exp_f32 v150, v150
    v_exp_f32 v151, v151
    v_cvt_pk_bf16_f32 v160, v148, v149
    v_cvt_pk_bf16_f32 v161, v150, v151
    v_exp_f32 v152, v152
    v_exp_f32 v153, v153
    v_mfma_f32_32x32x16_bf16 v[108:123], v[76:79], v[156:159], v[108:123]
    v_exp_f32 v154, v154
    v_exp_f32 v155, v155
    v_cvt_pk_bf16_f32 v162, v152, v153
    v_cvt_pk_bf16_f32 v163, v154, v155
    s_lshl_b32 s30, s66, 3
    s_add_u32 s30, s30, s26
    s_cmp_eq_u32 s30, 3
    s_nop 3
    s_cbranch_scc0 concat_heads__linear_kernel_hedgehog__mha_block__prompt_kernel_l2_skip
    s_lshl_b32 s4, s37, 11
    s_add_u32 s4, s4, 19464192
    v_and_b32 v2, 15, v0
    v_lshlrev_b32 v2, 7, v2
    v_add_u32 v2, s4, v2
    v_mov_b32 v3, 1
    s_mov_b32 s36, 0
    s_nop 0
concat_heads__linear_kernel_hedgehog__mha_block__prompt_kernel_spin1:
    buffer_load_dword v4, v2, s[8:11], 0 offen sc1
    s_add_u32 s36, s36, 1
    s_waitcnt vmcnt(0)
    v_cmp_ge_u32 vcc, v4, v3
    s_nop 0
    s_cmp_eq_u64 vcc, exec
    s_nop 1
    s_cbranch_scc1 concat_heads__linear_kernel_hedgehog__mha_block__prompt_kernel_spin1_ok
    s_cmp_ge_u32 s36, 400000
    s_cbranch_scc1 concat_heads__linear_kernel_hedgehog__mha_block__prompt_kernel_spin1_ok
    s_sleep 2
    s_branch concat_heads__linear_kernel_hedgehog__mha_block__prompt_kernel_spin1
concat_heads__linear_kernel_hedgehog__mha_block__prompt_kernel_spin1_ok:
    s_lshr_b32 s31, s38, 2
    s_lshr_b32 s32, s31, 1
    s_and_b32 s31, s31, 1
    s_lshl_b32 s30, s37, 17
    s_lshl_b32 s5, s32, 12
    s_add_u32 s30, s30, s5
    s_lshl_b32 s5, s31, 11
    s_add_u32 s30, s30, s5
    s_add_u32 s30, s30, 16777216
    s_and_b32 s5, s38, 3
    s_lshl_b32 s5, s5, 8
    v_lshrrev_b32 v2, 4, v0
    v_lshlrev_b32 v2, 15, v2
    v_and_b32 v3, 15, v0
    v_lshl_add_u32 v2, v3, 4, v2
    v_add_u32 v2, s5, v2
    buffer_load_dwordx4 v[164:167], v2, s[8:11], s30 offen offset:0 sc1
    buffer_load_dwordx4 v[168:171], v2, s[8:11], s30 offen offset:1024 sc1
    s_add_u32 s30, s30, 8192
    buffer_load_dwordx4 v[172:175], v2, s[8:11], s30 offen offset:0 sc1
    buffer_load_dwordx4 v[176:179], v2, s[8:11], s30 offen offset:1024 sc1
    s_add_u32 s30, s30, 8192
    buffer_load_dwordx4 v[180:183], v2, s[8:11], s30 offen offset:0 sc1
    buffer_load_dwordx4 v[184:187], v2, s[8:11], s30 offen offset:1024 sc1
    s_add_u32 s30, s30, 8192
    buffer_load_dwordx4 v[188:191], v2, s[8:11], s30 offen offset:0 sc1
    buffer_load_dwordx4 v[192:195], v2, s[8:11], s30 offen offset:1024 sc1
    s_waitcnt vmcnt(0)
    v_pk_add_f32 v[164:165], v[164:165], v[172:173]
    v_pk_add_f32 v[180:181], v[180:181], v[188:189]
    v_pk_add_f32 v[166:167], v[166:167], v[174:175]
    v_pk_add_f32 v[182:183], v[182:183], v[190:191]
    v_pk_add_f32 v[168:169], v[168:169], v[176:177]
    v_pk_add_f32 v[184:185], v[184:185], v[192:193]
    v_pk_add_f32 v[170:171], v[170:171], v[178:179]
    v_pk_add_f32 v[186:187], v[186:187], v[194:195]
    v_pk_add_f32 v[164:165], v[164:165], v[180:181]
    v_pk_add_f32 v[166:167], v[166:167], v[182:183]
    v_pk_add_f32 v[168:169], v[168:169], v[184:185]
    v_pk_add_f32 v[170:171], v[170:171], v[186:187]
    v_mov_b32 v172, v164
    v_mov_b32 v173, v165
    v_mov_b32 v174, v166
    v_mov_b32 v175, v167
    v_mov_b32 v176, v168
    v_mov_b32 v177, v169
    v_mov_b32 v178, v170
    v_mov_b32 v179, v171
    v_permlane32_swap_b32 v164, v172
    v_permlane32_swap_b32 v165, v173
    v_permlane32_swap_b32 v166, v174
    v_permlane32_swap_b32 v167, v175
    v_permlane32_swap_b32 v168, v176
    v_permlane32_swap_b32 v169, v177
    v_permlane32_swap_b32 v170, v178
    v_permlane32_swap_b32 v171, v179
    v_pk_add_f32 v[164:165], v[164:165], v[172:173]
    v_pk_add_f32 v[166:167], v[166:167], v[174:175]
    v_pk_add_f32 v[168:169], v[168:169], v[176:177]
    v_pk_add_f32 v[170:171], v[170:171], v[178:179]
    v_mov_b32 v172, v164
    v_mov_b32 v173, v165
    v_mov_b32 v174, v166
    v_mov_b32 v175, v167
    v_mov_b32 v176, v168
    v_mov_b32 v177, v169
    v_mov_b32 v178, v170
    v_mov_b32 v179, v171
    v_permlane16_swap_b32 v164, v172
    v_permlane16_swap_b32 v165, v173
    v_permlane16_swap_b32 v166, v174
    v_permlane16_swap_b32 v167, v175
    v_permlane16_swap_b32 v168, v176
    v_permlane16_swap_b32 v169, v177
    v_permlane16_swap_b32 v170, v178
    v_permlane16_swap_b32 v171, v179
    v_pk_add_f32 v[164:165], v[164:165], v[172:173]
    v_pk_add_f32 v[166:167], v[166:167], v[174:175]
    v_pk_add_f32 v[168:169], v[168:169], v[176:177]
    v_pk_add_f32 v[170:171], v[170:171], v[178:179]
    v_cvt_pk_bf16_f32 v180, v164, v165
    v_cvt_pk_bf16_f32 v181, v166, v167
    v_cvt_pk_bf16_f32 v182, v168, v169
    v_cvt_pk_bf16_f32 v183, v170, v171
    s_lshr_b32 s31, s38, 2
    s_lshl_b32 s30, s37, 2
    s_add_u32 s30, s30, s31
    s_lshl_b32 s30, s30, 10
    s_add_u32 s30, s30, 18874368
    s_and_b32 s5, s38, 3
    s_lshl_b32 s5, s5, 8
    s_add_u32 s30, s30, s5
    s_mov_b64 exec, 0xffff
    buffer_store_dwordx4 v[180:183], v1, s[8:11], s30 offen sc1
    s_mov_b64 exec, -1
    s_lshl_b32 s5, s38, 7
    s_add_u32 s4, s4, s5
    s_add_u32 s4, s4, 32768
    s_waitcnt vmcnt(0)
    v_mov_b32 v2, 0
    v_mov_b32 v3, 1
    s_mov_b64 exec, 1
    buffer_store_dword v3, v2, s[8:11], s4 offen sc1
    s_mov_b64 exec, -1
concat_heads__linear_kernel_hedgehog__mha_block__prompt_kernel_l2_skip:
    v_exp_f32 v124, v124
    v_exp_f32 v125, v125
    v_mfma_f32_32x32x16_bf16 v[108:123], v[80:83], v[160:163], v[108:123]
    v_exp_f32 v126, v126
    v_exp_f32 v127, v127
    v_cvt_pk_bf16_f32 v156, v124, v125
    v_cvt_pk_bf16_f32 v157, v126, v127
    v_exp_f32 v128, v128
    v_exp_f32 v129, v129
    v_mfma_f32_32x32x16_bf16 v[140:155], v[52:55], v[20:23], 0
    s_add_u32 s62, s67, 20480
    s_add_u32 s63, s67, 2117632
    buffer_load_dwordx4 v[44:47], v1, s[8:11], s62 offen offset:0
    buffer_load_dwordx4 v[48:51], v1, s[8:11], s62 offen offset:1024
    v_exp_f32 v130, v130
    v_exp_f32 v131, v131
    v_cvt_pk_bf16_f32 v158, v128, v129
    v_cvt_pk_bf16_f32 v159, v130, v131
    v_mfma_f32_32x32x16_bf16 v[140:155], v[56:59], v[24:27], v[140:155]
    v_exp_f32 v132, v132
    v_exp_f32 v133, v133
    buffer_load_dwordx4 v[76:79], v1, s[8:11], s63 offen offset:0
    buffer_load_dwordx4 v[80:83], v1, s[8:11], s63 offen offset:1024
    v_exp_f32 v134, v134
    v_exp_f32 v135, v135
    v_cvt_pk_bf16_f32 v160, v132, v133
    v_cvt_pk_bf16_f32 v161, v134, v135
    v_exp_f32 v136, v136
    v_exp_f32 v137, v137
    s_waitcnt vmcnt(12)
    v_mfma_f32_32x32x16_bf16 v[92:107], v[84:87], v[156:159], v[92:107]
    v_exp_f32 v138, v138
    v_exp_f32 v139, v139
    v_cvt_pk_bf16_f32 v162, v136, v137
    v_cvt_pk_bf16_f32 v163, v138, v139
    v_exp_f32 v140, v140
    v_exp_f32 v141, v141
    v_mfma_f32_32x32x16_bf16 v[92:107], v[88:91], v[160:163], v[92:107]
    v_exp_f32 v142, v142
    v_exp_f32 v143, v143
    v_cvt_pk_bf16_f32 v156, v140, v141
    v_cvt_pk_bf16_f32 v157, v142, v143
    v_exp_f32 v144, v144
    v_exp_f32 v145, v145
    s_waitcnt vmcnt(10)
    v_mfma_f32_32x32x16_bf16 v[124:139], v[28:31], v[12:15], 0
    v_exp_f32 v146, v146
    v_exp_f32 v147, v147
    v_cvt_pk_bf16_f32 v158, v144, v145
    v_cvt_pk_bf16_f32 v159, v146, v147
    v_mfma_f32_32x32x16_bf16 v[124:139], v[32:35], v[16:19], v[124:139]
    v_exp_f32 v148, v148
    v_exp_f32 v149, v149
    v_exp_f32 v150, v150
    v_exp_f32 v151, v151
    v_cvt_pk_bf16_f32 v160, v148, v149
    v_cvt_pk_bf16_f32 v161, v150, v151
    v_exp_f32 v152, v152
    v_exp_f32 v153, v153
    v_mfma_f32_32x32x16_bf16 v[108:123], v[84:87], v[156:159], v[108:123]
    v_exp_f32 v154, v154
    v_exp_f32 v155, v155
    v_cvt_pk_bf16_f32 v162, v152, v153
    v_cvt_pk_bf16_f32 v163, v154, v155
    v_exp_f32 v124, v124
    v_exp_f32 v125, v125
    v_mfma_f32_32x32x16_bf16 v[108:123], v[88:91], v[160:163], v[108:123]
    v_exp_f32 v126, v126
    v_exp_f32 v127, v127
    v_cvt_pk_bf16_f32 v156, v124, v125
    v_cvt_pk_bf16_f32 v157, v126, v127
    v_exp_f32 v128, v128
    v_exp_f32 v129, v129
    v_mfma_f32_32x32x16_bf16 v[140:155], v[28:31], v[20:23], 0
    buffer_load_dwordx4 v[52:55], v1, s[8:11], s62 offen offset:2048
    buffer_load_dwordx4 v[56:59], v1, s[8:11], s62 offen offset:3072
    v_exp_f32 v130, v130
    v_exp_f32 v131, v131
    v_cvt_pk_bf16_f32 v158, v128, v129
    v_cvt_pk_bf16_f32 v159, v130, v131
    v_mfma_f32_32x32x16_bf16 v[140:155], v[32:35], v[24:27], v[140:155]
    v_exp_f32 v132, v132
    v_exp_f32 v133, v133
    buffer_load_dwordx4 v[84:87], v1, s[8:11], s63 offen offset:2048
    buffer_load_dwordx4 v[88:91], v1, s[8:11], s63 offen offset:3072
    v_exp_f32 v134, v134
    v_exp_f32 v135, v135
    v_cvt_pk_bf16_f32 v160, v132, v133
    v_cvt_pk_bf16_f32 v161, v134, v135
    v_exp_f32 v136, v136
    v_exp_f32 v137, v137
    s_waitcnt vmcnt(12)
    v_mfma_f32_32x32x16_bf16 v[92:107], v[60:63], v[156:159], v[92:107]
    v_exp_f32 v138, v138
    v_exp_f32 v139, v139
    v_cvt_pk_bf16_f32 v162, v136, v137
    v_cvt_pk_bf16_f32 v163, v138, v139
    v_exp_f32 v140, v140
    v_exp_f32 v141, v141
    v_mfma_f32_32x32x16_bf16 v[92:107], v[64:67], v[160:163], v[92:107]
    v_exp_f32 v142, v142
    v_exp_f32 v143, v143
    v_cvt_pk_bf16_f32 v156, v140, v141
    v_cvt_pk_bf16_f32 v157, v142, v143
    v_exp_f32 v144, v144
    v_exp_f32 v145, v145
    s_waitcnt vmcnt(10)
    v_mfma_f32_32x32x16_bf16 v[124:139], v[36:39], v[12:15], 0
    v_exp_f32 v146, v146
    v_exp_f32 v147, v147
    v_cvt_pk_bf16_f32 v158, v144, v145
    v_cvt_pk_bf16_f32 v159, v146, v147
    v_mfma_f32_32x32x16_bf16 v[124:139], v[40:43], v[16:19], v[124:139]
    v_exp_f32 v148, v148
    v_exp_f32 v149, v149
    v_exp_f32 v150, v150
    v_exp_f32 v151, v151
    v_cvt_pk_bf16_f32 v160, v148, v149
    v_cvt_pk_bf16_f32 v161, v150, v151
    v_exp_f32 v152, v152
    v_exp_f32 v153, v153
    v_mfma_f32_32x32x16_bf16 v[108:123], v[60:63], v[156:159], v[108:123]
    v_exp_f32 v154, v154
    v_exp_f32 v155, v155
    v_cvt_pk_bf16_f32 v162, v152, v153
    v_cvt_pk_bf16_f32 v163, v154, v155
    v_exp_f32 v124, v124
    v_exp_f32 v125, v125
    v_mfma_f32_32x32x16_bf16 v[108:123], v[64:67], v[160:163], v[108:123]
    v_exp_f32 v126, v126
    v_exp_f32 v127, v127
    v_cvt_pk_bf16_f32 v156, v124, v125
    v_cvt_pk_bf16_f32 v157, v126, v127
    v_exp_f32 v128, v128
    v_exp_f32 v129, v129
    v_mfma_f32_32x32x16_bf16 v[140:155], v[36:39], v[20:23], 0
    s_add_u32 s62, s67, 24576
    s_add_u32 s63, s67, 2121728
    buffer_load_dwordx4 v[28:31], v1, s[8:11], s62 offen offset:0
    buffer_load_dwordx4 v[32:35], v1, s[8:11], s62 offen offset:1024
    v_exp_f32 v130, v130
    v_exp_f32 v131, v131
    v_cvt_pk_bf16_f32 v158, v128, v129
    v_cvt_pk_bf16_f32 v159, v130, v131
    v_mfma_f32_32x32x16_bf16 v[140:155], v[40:43], v[24:27], v[140:155]
    v_exp_f32 v132, v132
    v_exp_f32 v133, v133
    buffer_load_dwordx4 v[60:63], v1, s[8:11], s63 offen offset:0
    buffer_load_dwordx4 v[64:67], v1, s[8:11], s63 offen offset:1024
    v_exp_f32 v134, v134
    v_exp_f32 v135, v135
    v_cvt_pk_bf16_f32 v160, v132, v133
    v_cvt_pk_bf16_f32 v161, v134, v135
    v_exp_f32 v136, v136
    v_exp_f32 v137, v137
    s_waitcnt vmcnt(12)
    v_mfma_f32_32x32x16_bf16 v[92:107], v[68:71], v[156:159], v[92:107]
    v_exp_f32 v138, v138
    v_exp_f32 v139, v139
    v_cvt_pk_bf16_f32 v162, v136, v137
    v_cvt_pk_bf16_f32 v163, v138, v139
    v_exp_f32 v140, v140
    v_exp_f32 v141, v141
    v_mfma_f32_32x32x16_bf16 v[92:107], v[72:75], v[160:163], v[92:107]
    v_exp_f32 v142, v142
    v_exp_f32 v143, v143
    v_cvt_pk_bf16_f32 v156, v140, v141
    v_cvt_pk_bf16_f32 v157, v142, v143
    v_exp_f32 v144, v144
    v_exp_f32 v145, v145
    s_waitcnt vmcnt(10)
    v_mfma_f32_32x32x16_bf16 v[124:139], v[44:47], v[12:15], 0
    v_exp_f32 v146, v146
    v_exp_f32 v147, v147
    v_cvt_pk_bf16_f32 v158, v144, v145
    v_cvt_pk_bf16_f32 v159, v146, v147
    v_mfma_f32_32x32x16_bf16 v[124:139], v[48:51], v[16:19], v[124:139]
    v_exp_f32 v148, v148
    v_exp_f32 v149, v149
    v_exp_f32 v150, v150
    v_exp_f32 v151, v151
    v_cvt_pk_bf16_f32 v160, v148, v149
    v_cvt_pk_bf16_f32 v161, v150, v151
    v_exp_f32 v152, v152
    v_exp_f32 v153, v153
    v_mfma_f32_32x32x16_bf16 v[108:123], v[68:71], v[156:159], v[108:123]
    v_exp_f32 v154, v154
    v_exp_f32 v155, v155
    v_cvt_pk_bf16_f32 v162, v152, v153
    v_cvt_pk_bf16_f32 v163, v154, v155
    v_exp_f32 v124, v124
    v_exp_f32 v125, v125
    v_mfma_f32_32x32x16_bf16 v[108:123], v[72:75], v[160:163], v[108:123]
    v_exp_f32 v126, v126
    v_exp_f32 v127, v127
    v_cvt_pk_bf16_f32 v156, v124, v125
    v_cvt_pk_bf16_f32 v157, v126, v127
    v_exp_f32 v128, v128
    v_exp_f32 v129, v129
    v_mfma_f32_32x32x16_bf16 v[140:155], v[44:47], v[20:23], 0
    buffer_load_dwordx4 v[36:39], v1, s[8:11], s62 offen offset:2048
    buffer_load_dwordx4 v[40:43], v1, s[8:11], s62 offen offset:3072
    v_exp_f32 v130, v130
    v_exp_f32 v131, v131
    v_cvt_pk_bf16_f32 v158, v128, v129
    v_cvt_pk_bf16_f32 v159, v130, v131
    v_mfma_f32_32x32x16_bf16 v[140:155], v[48:51], v[24:27], v[140:155]
    v_exp_f32 v132, v132
    v_exp_f32 v133, v133
    buffer_load_dwordx4 v[68:71], v1, s[8:11], s63 offen offset:2048
    buffer_load_dwordx4 v[72:75], v1, s[8:11], s63 offen offset:3072
    v_exp_f32 v134, v134
    v_exp_f32 v135, v135
    v_cvt_pk_bf16_f32 v160, v132, v133
    v_cvt_pk_bf16_f32 v161, v134, v135
    v_exp_f32 v136, v136
    v_exp_f32 v137, v137
    s_waitcnt vmcnt(12)
    v_mfma_f32_32x32x16_bf16 v[92:107], v[76:79], v[156:159], v[92:107]
    v_exp_f32 v138, v138
    v_exp_f32 v139, v139
    v_cvt_pk_bf16_f32 v162, v136, v137
    v_cvt_pk_bf16_f32 v163, v138, v139
    v_exp_f32 v140, v140
    v_exp_f32 v141, v141
    v_mfma_f32_32x32x16_bf16 v[92:107], v[80:83], v[160:163], v[92:107]
    v_exp_f32 v142, v142
    v_exp_f32 v143, v143
    v_cvt_pk_bf16_f32 v156, v140, v141
    v_cvt_pk_bf16_f32 v157, v142, v143
    v_exp_f32 v144, v144
    v_exp_f32 v145, v145
    s_waitcnt vmcnt(10)
    v_mfma_f32_32x32x16_bf16 v[124:139], v[52:55], v[12:15], 0
    v_exp_f32 v146, v146
    v_exp_f32 v147, v147
    v_cvt_pk_bf16_f32 v158, v144, v145
    v_cvt_pk_bf16_f32 v159, v146, v147
    v_mfma_f32_32x32x16_bf16 v[124:139], v[56:59], v[16:19], v[124:139]
    v_exp_f32 v148, v148
    v_exp_f32 v149, v149
    v_exp_f32 v150, v150
    v_exp_f32 v151, v151
    v_cvt_pk_bf16_f32 v160, v148, v149
    v_cvt_pk_bf16_f32 v161, v150, v151
    v_exp_f32 v152, v152
    v_exp_f32 v153, v153
    v_mfma_f32_32x32x16_bf16 v[108:123], v[76:79], v[156:159], v[108:123]
    v_exp_f32 v154, v154
    v_exp_f32 v155, v155
    v_cvt_pk_bf16_f32 v162, v152, v153
    v_cvt_pk_bf16_f32 v163, v154, v155
    v_exp_f32 v124, v124
    v_exp_f32 v125, v125
    v_mfma_f32_32x32x16_bf16 v[108:123], v[80:83], v[160:163], v[108:123]
    v_exp_f32 v126, v126
    v_exp_f32 v127, v127
    v_cvt_pk_bf16_f32 v156, v124, v125
    v_cvt_pk_bf16_f32 v157, v126, v127
    v_exp_f32 v128, v128
    v_exp_f32 v129, v129
    v_mfma_f32_32x32x16_bf16 v[140:155], v[52:55], v[20:23], 0
    s_add_u32 s62, s67, 28672
    s_add_u32 s63, s67, 2125824
    buffer_load_dwordx4 v[44:47], v1, s[8:11], s62 offen offset:0
    buffer_load_dwordx4 v[48:51], v1, s[8:11], s62 offen offset:1024
    v_exp_f32 v130, v130
    v_exp_f32 v131, v131
    v_cvt_pk_bf16_f32 v158, v128, v129
    v_cvt_pk_bf16_f32 v159, v130, v131
    v_mfma_f32_32x32x16_bf16 v[140:155], v[56:59], v[24:27], v[140:155]
    v_exp_f32 v132, v132
    v_exp_f32 v133, v133
    buffer_load_dwordx4 v[76:79], v1, s[8:11], s63 offen offset:0
    buffer_load_dwordx4 v[80:83], v1, s[8:11], s63 offen offset:1024
    v_exp_f32 v134, v134
    v_exp_f32 v135, v135
    v_cvt_pk_bf16_f32 v160, v132, v133
    v_cvt_pk_bf16_f32 v161, v134, v135
    v_exp_f32 v136, v136
    v_exp_f32 v137, v137
    s_waitcnt vmcnt(12)
    v_mfma_f32_32x32x16_bf16 v[92:107], v[84:87], v[156:159], v[92:107]
    v_exp_f32 v138, v138
    v_exp_f32 v139, v139
    v_cvt_pk_bf16_f32 v162, v136, v137
    v_cvt_pk_bf16_f32 v163, v138, v139
    v_exp_f32 v140, v140
    v_exp_f32 v141, v141
    v_mfma_f32_32x32x16_bf16 v[92:107], v[88:91], v[160:163], v[92:107]
    v_exp_f32 v142, v142
    v_exp_f32 v143, v143
    v_cvt_pk_bf16_f32 v156, v140, v141
    v_cvt_pk_bf16_f32 v157, v142, v143
    v_exp_f32 v144, v144
    v_exp_f32 v145, v145
    s_waitcnt vmcnt(10)
    v_mfma_f32_32x32x16_bf16 v[124:139], v[28:31], v[12:15], 0
    v_exp_f32 v146, v146
    v_exp_f32 v147, v147
    v_cvt_pk_bf16_f32 v158, v144, v145
    v_cvt_pk_bf16_f32 v159, v146, v147
    v_mfma_f32_32x32x16_bf16 v[124:139], v[32:35], v[16:19], v[124:139]
    v_exp_f32 v148, v148
    v_exp_f32 v149, v149
    v_exp_f32 v150, v150
    v_exp_f32 v151, v151
    v_cvt_pk_bf16_f32 v160, v148, v149
    v_cvt_pk_bf16_f32 v161, v150, v151
    v_exp_f32 v152, v152
    v_exp_f32 v153, v153
    v_mfma_f32_32x32x16_bf16 v[108:123], v[84:87], v[156:159], v[108:123]
    v_exp_f32 v154, v154
    v_exp_f32 v155, v155
    v_cvt_pk_bf16_f32 v162, v152, v153
    v_cvt_pk_bf16_f32 v163, v154, v155
    v_exp_f32 v124, v124
    v_exp_f32 v125, v125
    v_mfma_f32_32x32x16_bf16 v[108:123], v[88:91], v[160:163], v[108:123]
    v_exp_f32 v126, v126
    v_exp_f32 v127, v127
    v_cvt_pk_bf16_f32 v156, v124, v125
    v_cvt_pk_bf16_f32 v157, v126, v127
    v_exp_f32 v128, v128
    v_exp_f32 v129, v129
    v_mfma_f32_32x32x16_bf16 v[140:155], v[28:31], v[20:23], 0
    buffer_load_dwordx4 v[52:55], v1, s[8:11], s62 offen offset:2048
    buffer_load_dwordx4 v[56:59], v1, s[8:11], s62 offen offset:3072
    v_exp_f32 v130, v130
    v_exp_f32 v131, v131
    v_cvt_pk_bf16_f32 v158, v128, v129
    v_cvt_pk_bf16_f32 v159, v130, v131
    v_mfma_f32_32x32x16_bf16 v[140:155], v[32:35], v[24:27], v[140:155]
    v_exp_f32 v132, v132
    v_exp_f32 v133, v133
    buffer_load_dwordx4 v[84:87], v1, s[8:11], s63 offen offset:2048
    buffer_load_dwordx4 v[88:91], v1, s[8:11], s63 offen offset:3072
    v_exp_f32 v134, v134
    v_exp_f32 v135, v135
    v_cvt_pk_bf16_f32 v160, v132, v133
    v_cvt_pk_bf16_f32 v161, v134, v135
    v_exp_f32 v136, v136
    v_exp_f32 v137, v137
    s_waitcnt vmcnt(12)
    v_mfma_f32_32x32x16_bf16 v[92:107], v[60:63], v[156:159], v[92:107]
    v_exp_f32 v138, v138
    v_exp_f32 v139, v139
    v_cvt_pk_bf16_f32 v162, v136, v137
    v_cvt_pk_bf16_f32 v163, v138, v139
    v_exp_f32 v140, v140
    v_exp_f32 v141, v141
    v_mfma_f32_32x32x16_bf16 v[92:107], v[64:67], v[160:163], v[92:107]
    v_exp_f32 v142, v142
    v_exp_f32 v143, v143
    v_cvt_pk_bf16_f32 v156, v140, v141
    v_cvt_pk_bf16_f32 v157, v142, v143
    v_exp_f32 v144, v144
    v_exp_f32 v145, v145
    s_waitcnt vmcnt(10)
    v_mfma_f32_32x32x16_bf16 v[124:139], v[36:39], v[12:15], 0
    v_exp_f32 v146, v146
    v_exp_f32 v147, v147
    v_cvt_pk_bf16_f32 v158, v144, v145
    v_cvt_pk_bf16_f32 v159, v146, v147
    v_mfma_f32_32x32x16_bf16 v[124:139], v[40:43], v[16:19], v[124:139]
    v_exp_f32 v148, v148
    v_exp_f32 v149, v149
    v_exp_f32 v150, v150
    v_exp_f32 v151, v151
    v_cvt_pk_bf16_f32 v160, v148, v149
    v_cvt_pk_bf16_f32 v161, v150, v151
    v_exp_f32 v152, v152
    v_exp_f32 v153, v153
    v_mfma_f32_32x32x16_bf16 v[108:123], v[60:63], v[156:159], v[108:123]
    v_exp_f32 v154, v154
    v_exp_f32 v155, v155
    v_cvt_pk_bf16_f32 v162, v152, v153
    v_cvt_pk_bf16_f32 v163, v154, v155
    v_exp_f32 v124, v124
    v_exp_f32 v125, v125
    v_mfma_f32_32x32x16_bf16 v[108:123], v[64:67], v[160:163], v[108:123]
    v_exp_f32 v126, v126
    v_exp_f32 v127, v127
    v_cvt_pk_bf16_f32 v156, v124, v125
    v_cvt_pk_bf16_f32 v157, v126, v127
    v_exp_f32 v128, v128
    v_exp_f32 v129, v129
    v_mfma_f32_32x32x16_bf16 v[140:155], v[36:39], v[20:23], 0
    v_exp_f32 v130, v130
    v_exp_f32 v131, v131
    v_cvt_pk_bf16_f32 v158, v128, v129
    v_cvt_pk_bf16_f32 v159, v130, v131
    v_mfma_f32_32x32x16_bf16 v[140:155], v[40:43], v[24:27], v[140:155]
    v_exp_f32 v132, v132
    v_exp_f32 v133, v133
    v_exp_f32 v134, v134
    v_exp_f32 v135, v135
    v_cvt_pk_bf16_f32 v160, v132, v133
    v_cvt_pk_bf16_f32 v161, v134, v135
    v_exp_f32 v136, v136
    v_exp_f32 v137, v137
    s_waitcnt vmcnt(8)
    v_mfma_f32_32x32x16_bf16 v[92:107], v[68:71], v[156:159], v[92:107]
    v_exp_f32 v138, v138
    v_exp_f32 v139, v139
    v_cvt_pk_bf16_f32 v162, v136, v137
    v_cvt_pk_bf16_f32 v163, v138, v139
    v_exp_f32 v140, v140
    v_exp_f32 v141, v141
    v_mfma_f32_32x32x16_bf16 v[92:107], v[72:75], v[160:163], v[92:107]
    v_exp_f32 v142, v142
    v_exp_f32 v143, v143
    v_cvt_pk_bf16_f32 v156, v140, v141
    v_cvt_pk_bf16_f32 v157, v142, v143
    v_exp_f32 v144, v144
    v_exp_f32 v145, v145
    s_waitcnt vmcnt(6)
    v_mfma_f32_32x32x16_bf16 v[124:139], v[44:47], v[12:15], 0
    v_exp_f32 v146, v146
    v_exp_f32 v147, v147
    v_cvt_pk_bf16_f32 v158, v144, v145
    v_cvt_pk_bf16_f32 v159, v146, v147
    v_mfma_f32_32x32x16_bf16 v[124:139], v[48:51], v[16:19], v[124:139]
    v_exp_f32 v148, v148
    v_exp_f32 v149, v149
    v_exp_f32 v150, v150
    v_exp_f32 v151, v151
    v_cvt_pk_bf16_f32 v160, v148, v149
    v_cvt_pk_bf16_f32 v161, v150, v151
    v_exp_f32 v152, v152
    v_exp_f32 v153, v153
    v_mfma_f32_32x32x16_bf16 v[108:123], v[68:71], v[156:159], v[108:123]
    v_exp_f32 v154, v154
    v_exp_f32 v155, v155
    v_cvt_pk_bf16_f32 v162, v152, v153
    v_cvt_pk_bf16_f32 v163, v154, v155
    v_exp_f32 v124, v124
    v_exp_f32 v125, v125
    v_mfma_f32_32x32x16_bf16 v[108:123], v[72:75], v[160:163], v[108:123]
    v_exp_f32 v126, v126
    v_exp_f32 v127, v127
    v_cvt_pk_bf16_f32 v156, v124, v125
    v_cvt_pk_bf16_f32 v157, v126, v127
    v_exp_f32 v128, v128
    v_exp_f32 v129, v129
    v_mfma_f32_32x32x16_bf16 v[140:155], v[44:47], v[20:23], 0
    v_exp_f32 v130, v130
    v_exp_f32 v131, v131
    v_cvt_pk_bf16_f32 v158, v128, v129
    v_cvt_pk_bf16_f32 v159, v130, v131
    v_mfma_f32_32x32x16_bf16 v[140:155], v[48:51], v[24:27], v[140:155]
    v_exp_f32 v132, v132
    v_exp_f32 v133, v133
    v_exp_f32 v134, v134
    v_exp_f32 v135, v135
    v_cvt_pk_bf16_f32 v160, v132, v133
    v_cvt_pk_bf16_f32 v161, v134, v135
    v_exp_f32 v136, v136
    v_exp_f32 v137, v137
    s_waitcnt vmcnt(4)
    v_mfma_f32_32x32x16_bf16 v[92:107], v[76:79], v[156:159], v[92:107]
    v_exp_f32 v138, v138
    v_exp_f32 v139, v139
    v_cvt_pk_bf16_f32 v162, v136, v137
    v_cvt_pk_bf16_f32 v163, v138, v139
    v_exp_f32 v140, v140
    v_exp_f32 v141, v141
    v_mfma_f32_32x32x16_bf16 v[92:107], v[80:83], v[160:163], v[92:107]
    v_exp_f32 v142, v142
    v_exp_f32 v143, v143
    v_cvt_pk_bf16_f32 v156, v140, v141
    v_cvt_pk_bf16_f32 v157, v142, v143
    v_exp_f32 v144, v144
    v_exp_f32 v145, v145
    s_waitcnt vmcnt(2)
    v_mfma_f32_32x32x16_bf16 v[124:139], v[52:55], v[12:15], 0
    v_exp_f32 v146, v146
    v_exp_f32 v147, v147
    v_cvt_pk_bf16_f32 v158, v144, v145
    v_cvt_pk_bf16_f32 v159, v146, v147
    v_mfma_f32_32x32x16_bf16 v[124:139], v[56:59], v[16:19], v[124:139]
    v_exp_f32 v148, v148
    v_exp_f32 v149, v149
    v_exp_f32 v150, v150
    v_exp_f32 v151, v151
    v_cvt_pk_bf16_f32 v160, v148, v149
    v_cvt_pk_bf16_f32 v161, v150, v151
    v_exp_f32 v152, v152
    v_exp_f32 v153, v153
    v_mfma_f32_32x32x16_bf16 v[108:123], v[76:79], v[156:159], v[108:123]
    v_exp_f32 v154, v154
    v_exp_f32 v155, v155
    v_cvt_pk_bf16_f32 v162, v152, v153
    v_cvt_pk_bf16_f32 v163, v154, v155
    v_exp_f32 v124, v124
    v_exp_f32 v125, v125
    v_mfma_f32_32x32x16_bf16 v[108:123], v[80:83], v[160:163], v[108:123]
    v_exp_f32 v126, v126
    v_exp_f32 v127, v127
    v_cvt_pk_bf16_f32 v156, v124, v125
    v_cvt_pk_bf16_f32 v157, v126, v127
    v_exp_f32 v128, v128
    v_exp_f32 v129, v129
    v_mfma_f32_32x32x16_bf16 v[140:155], v[52:55], v[20:23], 0
    v_exp_f32 v130, v130
    v_exp_f32 v131, v131
    v_cvt_pk_bf16_f32 v158, v128, v129
    v_cvt_pk_bf16_f32 v159, v130, v131
    v_mfma_f32_32x32x16_bf16 v[140:155], v[56:59], v[24:27], v[140:155]
    v_exp_f32 v132, v132
    v_exp_f32 v133, v133
    v_exp_f32 v134, v134
    v_exp_f32 v135, v135
    v_cvt_pk_bf16_f32 v160, v132, v133
    v_cvt_pk_bf16_f32 v161, v134, v135
    v_exp_f32 v136, v136
    v_exp_f32 v137, v137
    s_waitcnt vmcnt(0)
    v_mfma_f32_32x32x16_bf16 v[92:107], v[84:87], v[156:159], v[92:107]
    v_exp_f32 v138, v138
    v_exp_f32 v139, v139
    v_cvt_pk_bf16_f32 v162, v136, v137
    v_cvt_pk_bf16_f32 v163, v138, v139
    v_exp_f32 v140, v140
    v_exp_f32 v141, v141
    v_mfma_f32_32x32x16_bf16 v[92:107], v[88:91], v[160:163], v[92:107]
    v_exp_f32 v142, v142
    v_exp_f32 v143, v143
    v_cvt_pk_bf16_f32 v156, v140, v141
    v_cvt_pk_bf16_f32 v157, v142, v143
    v_exp_f32 v144, v144
    v_exp_f32 v145, v145
    v_exp_f32 v146, v146
    v_exp_f32 v147, v147
    v_cvt_pk_bf16_f32 v158, v144, v145
    v_cvt_pk_bf16_f32 v159, v146, v147
    v_exp_f32 v148, v148
    v_exp_f32 v149, v149
    v_exp_f32 v150, v150
    v_exp_f32 v151, v151
    v_cvt_pk_bf16_f32 v160, v148, v149
    v_cvt_pk_bf16_f32 v161, v150, v151
    v_exp_f32 v152, v152
    v_exp_f32 v153, v153
    v_mfma_f32_32x32x16_bf16 v[108:123], v[84:87], v[156:159], v[108:123]
    v_exp_f32 v154, v154
    v_exp_f32 v155, v155
    v_cvt_pk_bf16_f32 v162, v152, v153
    v_cvt_pk_bf16_f32 v163, v154, v155
    s_nop 0
    s_nop 0
    v_mfma_f32_32x32x16_bf16 v[108:123], v[88:91], v[160:163], v[108:123]
    s_mul_i32 s30, s60, 24576
    v_add_u32 v164, s30, v1
    s_cmp_lt_u32 s26, 4
    s_nop 7
    s_cbranch_scc0 concat_heads__linear_kernel_hedgehog__mha_block__prompt_kernel_fin_late
    s_lshl_b32 s30, s61, 12
    v_add_u32 v164, s30, v164
    ds_write_b128 v164, v[92:95] offset:22784
    ds_write_b128 v164, v[96:99] offset:23808
    ds_write_b128 v164, v[100:103] offset:24832
    ds_write_b128 v164, v[104:107] offset:25856
    ds_write_b128 v164, v[108:111] offset:35072
    ds_write_b128 v164, v[112:115] offset:36096
    ds_write_b128 v164, v[116:119] offset:37120
    ds_write_b128 v164, v[120:123] offset:38144
    s_cmp_eq_u32 s66, 0
    s_cbranch_scc0 concat_heads__linear_kernel_hedgehog__mha_block__prompt_kernel_aend_done
    s_lshl_b32 s30, s38, 2
    s_add_u32 s5, s30, s26
    s_lshl_b32 s30, s5, 11
    s_add_u32 s30, s30, s39
    s_add_u32 s30, s30, 0
    buffer_load_dwordx4 v[172:175], v1, s[8:11], s30 offen
    buffer_load_dwordx4 v[176:179], v1, s[8:11], s30 offen offset:1024
    v_lshrrev_b32 v2, 5, v0
    v_lshlrev_b32 v2, 2, v2
    v_bfe_u32 v3, v0, 2, 2
    v_add_u32 v2, v2, v3
    v_mul_u32_u24 v2, 56, v2
    v_bfe_u32 v3, v0, 4, 1
    v_lshl_add_u32 v2, v3, 5, v2
    v_and_b32 v4, 3, v0
    v_lshl_add_u32 v2, v4, 3, v2
    v_add_u32 v2, 151552, v2
    ds_read_b64_tr_b16 v[180:181], v2 offset:0
    ds_read_b64_tr_b16 v[182:183], v2 offset:448
    ds_read_b64_tr_b16 v[184:185], v2 offset:896
    ds_read_b64_tr_b16 v[186:187], v2 offset:1344
    s_waitcnt vmcnt(0) lgkmcnt(0)
    s_mov_b64 exec, s[34:35]
    v_mov_b32 v178, 0
    v_mov_b32 v179, 0
    s_mov_b64 exec, -1
    v_mfma_f32_32x32x16_bf16 v[124:139], v[180:183], v[172:175], 0
    v_mfma_f32_32x32x16_bf16 v[124:139], v[184:187], v[176:179], v[124:139]
    s_mov_b64 exec, s[34:35]
    s_nop 10
    v_mov_b32 v136, v132
    v_mov_b32 v137, v133
    v_mov_b32 v138, v134
    v_mov_b32 v139, v135
    s_mov_b64 exec, -1
    v_max3_f32 v2, v124, v125, v126
    v_min3_f32 v3, v124, v125, v126
    v_max3_f32 v2, v2, v127, v128
    v_min3_f32 v3, v3, v127, v128
    v_max3_f32 v2, v2, v129, v130
    v_min3_f32 v3, v3, v129, v130
    v_max3_f32 v2, v2, v131, v132
    v_min3_f32 v3, v3, v131, v132
    v_max3_f32 v2, v2, v133, v134
    v_min3_f32 v3, v3, v133, v134
    v_max3_f32 v2, v2, v135, v136
    v_min3_f32 v3, v3, v135, v136
    v_max3_f32 v2, v2, v137, v138
    v_min3_f32 v3, v3, v137, v138
    v_max_f32 v2, v2, v139
    v_min_f32 v3, v3, v139
    v_mov_b32 v4, v2
    v_mov_b32 v5, v2
    s_nop 1
    v_permlane32_swap_b32 v4, v5
    v_max_f32 v2, v4, v5
    v_mov_b32 v4, v3
    v_mov_b32 v5, v3
    s_nop 1
    v_permlane32_swap_b32 v4, v5
    v_min_f32 v3, v4, v5
    v_mul_f32 v2, s0, v2
    v_mul_f32 v3, s0, v3
    v_mov_b32 v4, v2
    v_mov_b32 v5, v2
    v_pk_fma_f32 v[140:141], v[124:125], s[0:1], v[4:5] neg_lo:[0,0,1] neg_hi:[0,0,1]
    v_pk_fma_f32 v[142:143], v[126:127], s[0:1], v[4:5] neg_lo:[0,0,1] neg_hi:[0,0,1]
    v_pk_fma_f32 v[144:145], v[128:129], s[0:1], v[4:5] neg_lo:[0,0,1] neg_hi:[0,0,1]
    v_pk_fma_f32 v[146:147], v[130:131], s[0:1], v[4:5] neg_lo:[0,0,1] neg_hi:[0,0,1]
    v_pk_fma_f32 v[148:149], v[132:133], s[0:1], v[4:5] neg_lo:[0,0,1] neg_hi:[0,0,1]
    v_pk_fma_f32 v[150:151], v[134:135], s[0:1], v[4:5] neg_lo:[0,0,1] neg_hi:[0,0,1]
    v_pk_fma_f32 v[152:153], v[136:137], s[0:1], v[4:5] neg_lo:[0,0,1] neg_hi:[0,0,1]
    v_pk_fma_f32 v[154:155], v[138:139], s[0:1], v[4:5] neg_lo:[0,0,1] neg_hi:[0,0,1]
    v_exp_f32 v140, v140
    v_exp_f32 v141, v141
    v_exp_f32 v142, v142
    v_exp_f32 v143, v143
    v_exp_f32 v144, v144
    v_exp_f32 v145, v145
    v_exp_f32 v146, v146
    v_exp_f32 v147, v147
    v_exp_f32 v148, v148
    v_exp_f32 v149, v149
    v_exp_f32 v150, v150
    v_exp_f32 v151, v151
    v_exp_f32 v152, v152
    v_exp_f32 v153, v153
    v_exp_f32 v154, v154
    v_exp_f32 v155, v155
    s_mov_b64 exec, s[34:35]
    v_mov_b32 v152, 0
    v_mov_b32 v153, 0
    v_mov_b32 v154, 0
    v_mov_b32 v155, 0
    s_mov_b64 exec, -1
    v_pk_add_f32 v[188:189], v[140:141], v[142:143]
    v_pk_add_f32 v[188:189], v[188:189], v[144:145]
    v_pk_add_f32 v[188:189], v[188:189], v[146:147]
    v_pk_add_f32 v[188:189], v[188:189], v[148:149]
    v_pk_add_f32 v[188:189], v[188:189], v[150:151]
    v_pk_add_f32 v[188:189], v[188:189], v[152:153]
    v_pk_add_f32 v[188:189], v[188:189], v[154:155]
    v_add_f32 v6, v188, v189
    v_mov_b32 v4, v6
    v_mov_b32 v5, v6
    s_nop 1
    v_permlane32_swap_b32 v4, v5
    v_add_f32 v6, v4, v5
    v_rcp_f32 v6, v6
    s_nop 0
    v_mov_b32 v4, v6
    v_mov_b32 v5, v6
    v_pk_mul_f32 v[140:141], v[140:141], v[4:5]
    v_pk_mul_f32 v[142:143], v[142:143], v[4:5]
    v_pk_mul_f32 v[144:145], v[144:145], v[4:5]
    v_pk_mul_f32 v[146:147], v[146:147], v[4:5]
    v_pk_mul_f32 v[148:149], v[148:149], v[4:5]
    v_pk_mul_f32 v[150:151], v[150:151], v[4:5]
    v_pk_mul_f32 v[152:153], v[152:153], v[4:5]
    v_pk_mul_f32 v[154:155], v[154:155], v[4:5]
    v_cvt_pk_bf16_f32 v188, v140, v141
    v_cvt_pk_bf16_f32 v189, v142, v143
    v_cvt_pk_bf16_f32 v190, v144, v145
    v_cvt_pk_bf16_f32 v191, v146, v147
    v_cvt_pk_bf16_f32 v192, v148, v149
    v_cvt_pk_bf16_f32 v193, v150, v151
    v_cvt_pk_bf16_f32 v194, v152, v153
    v_cvt_pk_bf16_f32 v195, v154, v155
    v_mov_b32 v4, v3
    v_mov_b32 v5, v3
    v_pk_fma_f32 v[140:141], v[124:125], s[0:1], v[4:5] neg_lo:[1,0,0] neg_hi:[1,0,0]
    v_pk_fma_f32 v[142:143], v[126:127], s[0:1], v[4:5] neg_lo:[1,0,0] neg_hi:[1,0,0]
    v_pk_fma_f32 v[144:145], v[128:129], s[0:1], v[4:5] neg_lo:[1,0,0] neg_hi:[1,0,0]
    v_pk_fma_f32 v[146:147], v[130:131], s[0:1], v[4:5] neg_lo:[1,0,0] neg_hi:[1,0,0]
    v_pk_fma_f32 v[148:149], v[132:133], s[0:1], v[4:5] neg_lo:[1,0,0] neg_hi:[1,0,0]
    v_pk_fma_f32 v[150:151], v[134:135], s[0:1], v[4:5] neg_lo:[1,0,0] neg_hi:[1,0,0]
    v_pk_fma_f32 v[152:153], v[136:137], s[0:1], v[4:5] neg_lo:[1,0,0] neg_hi:[1,0,0]
    v_pk_fma_f32 v[154:155], v[138:139], s[0:1], v[4:5] neg_lo:[1,0,0] neg_hi:[1,0,0]
    v_exp_f32 v140, v140
    v_exp_f32 v141, v141
    v_exp_f32 v142, v142
    v_exp_f32 v143, v143
    v_exp_f32 v144, v144
    v_exp_f32 v145, v145
    v_exp_f32 v146, v146
    v_exp_f32 v147, v147
    v_exp_f32 v148, v148
    v_exp_f32 v149, v149
    v_exp_f32 v150, v150
    v_exp_f32 v151, v151
    v_exp_f32 v152, v152
    v_exp_f32 v153, v153
    v_exp_f32 v154, v154
    v_exp_f32 v155, v155
    s_mov_b64 exec, s[34:35]
    v_mov_b32 v152, 0
    v_mov_b32 v153, 0
    v_mov_b32 v154, 0
    v_mov_b32 v155, 0
    s_mov_b64 exec, -1
    v_pk_add_f32 v[196:197], v[140:141], v[142:143]
    v_pk_add_f32 v[196:197], v[196:197], v[144:145]
    v_pk_add_f32 v[196:197], v[196:197], v[146:147]
    v_pk_add_f32 v[196:197], v[196:197], v[148:149]
    v_pk_add_f32 v[196:197], v[196:197], v[150:151]
    v_pk_add_f32 v[196:197], v[196:197], v[152:153]
    v_pk_add_f32 v[196:197], v[196:197], v[154:155]
    v_add_f32 v6, v196, v197
    v_mov_b32 v4, v6
    v_mov_b32 v5, v6
    s_nop 1
    v_permlane32_swap_b32 v4, v5
    v_add_f32 v6, v4, v5
    v_rcp_f32 v6, v6
    s_nop 0
    v_mov_b32 v4, v6
    v_mov_b32 v5, v6
    v_pk_mul_f32 v[140:141], v[140:141], v[4:5]
    v_pk_mul_f32 v[142:143], v[142:143], v[4:5]
    v_pk_mul_f32 v[144:145], v[144:145], v[4:5]
    v_pk_mul_f32 v[146:147], v[146:147], v[4:5]
    v_pk_mul_f32 v[148:149], v[148:149], v[4:5]
    v_pk_mul_f32 v[150:151], v[150:151], v[4:5]
    v_pk_mul_f32 v[152:153], v[152:153], v[4:5]
    v_pk_mul_f32 v[154:155], v[154:155], v[4:5]
    v_cvt_pk_bf16_f32 v196, v140, v141
    v_cvt_pk_bf16_f32 v197, v142, v143
    v_cvt_pk_bf16_f32 v198, v144, v145
    v_cvt_pk_bf16_f32 v199, v146, v147
    v_cvt_pk_bf16_f32 v200, v148, v149
    v_cvt_pk_bf16_f32 v201, v150, v151
    v_cvt_pk_bf16_f32 v202, v152, v153
    v_cvt_pk_bf16_f32 v203, v154, v155
    s_lshl_b32 s4, s37, 11
    s_add_u32 s4, s4, 19496960
    v_and_b32 v2, 15, v0
    v_lshlrev_b32 v2, 7, v2
    v_add_u32 v2, s4, v2
    v_mov_b32 v3, 1
    s_mov_b32 s36, 0
    s_nop 0
concat_heads__linear_kernel_hedgehog__mha_block__prompt_kernel_spin2:
    buffer_load_dword v4, v2, s[8:11], 0 offen sc1
    s_add_u32 s36, s36, 1
    s_waitcnt vmcnt(0)
    v_cmp_ge_u32 vcc, v4, v3
    s_nop 0
    s_cmp_eq_u64 vcc, exec
    s_nop 1
    s_cbranch_scc1 concat_heads__linear_kernel_hedgehog__mha_block__prompt_kernel_spin2_ok
    s_cmp_ge_u32 s36, 400000
    s_cbranch_scc1 concat_heads__linear_kernel_hedgehog__mha_block__prompt_kernel_spin2_ok
    s_sleep 2
    s_branch concat_heads__linear_kernel_hedgehog__mha_block__prompt_kernel_spin2
concat_heads__linear_kernel_hedgehog__mha_block__prompt_kernel_spin2_ok:
    s_lshl_b32 s30, s37, 12
    s_add_u32 s30, s30, 18874368
    buffer_load_dwordx4 v[92:95], v1, s[8:11], s30 offen offset:0 sc1
    buffer_load_dwordx4 v[96:99], v1, s[8:11], s30 offen offset:1024 sc1
    buffer_load_dwordx4 v[100:103], v1, s[8:11], s30 offen offset:2048 sc1
    buffer_load_dwordx4 v[104:107], v1, s[8:11], s30 offen offset:3072 sc1
    s_waitcnt vmcnt(3)
    v_mfma_f32_32x32x16_bf16 v[124:139], v[92:95], v[188:191], 0
    s_waitcnt vmcnt(2)
    v_mfma_f32_32x32x16_bf16 v[124:139], v[96:99], v[192:195], v[124:139]
    s_waitcnt vmcnt(1)
    v_mfma_f32_32x32x16_bf16 v[124:139], v[100:103], v[196:199], v[124:139]
    s_waitcnt vmcnt(0)
    v_mfma_f32_32x32x16_bf16 v[124:139], v[104:107], v[200:203], v[124:139]
    s_lshl_b32 s65, s5, 4
    s_add_u32 s65, s65, s37
    s_lshl_b32 s65, s65, 11
    s_add_u32 s65, s65, 12582912
    s_nop 7
    v_mov_b32 v2, v136
    v_mov_b32 v3, v136
    s_nop 1
    v_permlane32_swap_b32 v2, v3
    v_add_f32 v3, 0x358637bd, v3
    v_rcp_f32 v4, v3
    s_nop 0
    v_mov_b32 v5, v4
    v_pk_mul_f32 v[124:125], v[124:125], v[4:5]
    v_pk_mul_f32 v[126:127], v[126:127], v[4:5]
    v_pk_mul_f32 v[128:129], v[128:129], v[4:5]
    v_pk_mul_f32 v[130:131], v[130:131], v[4:5]
    v_pk_mul_f32 v[132:133], v[132:133], v[4:5]
    v_pk_mul_f32 v[134:135], v[134:135], v[4:5]
    v_pk_mul_f32 v[136:137], v[136:137], v[4:5]
    v_pk_mul_f32 v[138:139], v[138:139], v[4:5]
    v_cvt_pk_bf16_f32 v156, v124, v125
    v_cvt_pk_bf16_f32 v157, v126, v127
    v_cvt_pk_bf16_f32 v158, v128, v129
    v_cvt_pk_bf16_f32 v159, v130, v131
    v_cvt_pk_bf16_f32 v160, v132, v133
    v_cvt_pk_bf16_f32 v161, v134, v135
    v_cvt_pk_bf16_f32 v162, v136, v137
    v_cvt_pk_bf16_f32 v163, v138, v139
    s_mov_b64 exec, s[34:35]
    v_mov_b32 v162, 0
    v_mov_b32 v163, 0
    s_mov_b64 exec, -1
    buffer_store_dwordx4 v[156:159], v1, s[8:11], s65 offen offset:0 sc1
    buffer_store_dwordx4 v[160:163], v1, s[8:11], s65 offen offset:1024 sc1
    s_nop 1
concat_heads__linear_kernel_hedgehog__mha_block__prompt_kernel_aend_done:
    s_waitcnt lgkmcnt(0)
    s_barrier
    s_branch concat_heads__linear_kernel_hedgehog__mha_block__prompt_kernel_fin_join
concat_heads__linear_kernel_hedgehog__mha_block__prompt_kernel_fin_late:
    s_cmp_eq_u32 s61, 2
    s_cbranch_scc0 concat_heads__linear_kernel_hedgehog__mha_block__prompt_kernel_fin_late_b
    ds_write_b128 v164, v[108:111] offset:43264
    ds_write_b128 v164, v[112:115] offset:44288
    ds_write_b128 v164, v[116:119] offset:45312
    ds_write_b128 v164, v[120:123] offset:46336
    s_lshl_b32 s30, s38, 2
    s_lshl_b32 s31, s60, 1
    s_add_u32 s30, s30, s31
    s_add_u32 s30, s30, 0
    s_lshl_b32 s65, s30, 4
    s_add_u32 s65, s65, s37
    s_lshl_b32 s65, s65, 11
    s_add_u32 s65, s65, 14680064
    s_waitcnt lgkmcnt(0)
    s_barrier
    ds_read_b128 v[124:127], v164 offset:22784
    ds_read_b128 v[128:131], v164 offset:23808
    ds_read_b128 v[132:135], v164 offset:24832
    ds_read_b128 v[136:139], v164 offset:25856
    ds_read_b128 v[140:143], v164 offset:26880
    ds_read_b128 v[144:147], v164 offset:27904
    ds_read_b128 v[148:151], v164 offset:28928
    ds_read_b128 v[152:155], v164 offset:29952
    ds_read_b128 v[108:111], v164 offset:30976
    ds_read_b128 v[112:115], v164 offset:32000
    ds_read_b128 v[116:119], v164 offset:33024
    ds_read_b128 v[120:123], v164 offset:34048
    s_waitcnt lgkmcnt(8)
    v_pk_add_f32 v[92:93], v[92:93], v[124:125]
    v_pk_add_f32 v[94:95], v[94:95], v[126:127]
    v_pk_add_f32 v[96:97], v[96:97], v[128:129]
    v_pk_add_f32 v[98:99], v[98:99], v[130:131]
    v_pk_add_f32 v[100:101], v[100:101], v[132:133]
    v_pk_add_f32 v[102:103], v[102:103], v[134:135]
    v_pk_add_f32 v[104:105], v[104:105], v[136:137]
    v_pk_add_f32 v[106:107], v[106:107], v[138:139]
    s_waitcnt lgkmcnt(4)
    v_pk_add_f32 v[92:93], v[92:93], v[140:141]
    v_pk_add_f32 v[94:95], v[94:95], v[142:143]
    v_pk_add_f32 v[96:97], v[96:97], v[144:145]
    v_pk_add_f32 v[98:99], v[98:99], v[146:147]
    v_pk_add_f32 v[100:101], v[100:101], v[148:149]
    v_pk_add_f32 v[102:103], v[102:103], v[150:151]
    v_pk_add_f32 v[104:105], v[104:105], v[152:153]
    v_pk_add_f32 v[106:107], v[106:107], v[154:155]
    s_waitcnt lgkmcnt(0)
    v_pk_add_f32 v[92:93], v[92:93], v[108:109]
    v_pk_add_f32 v[94:95], v[94:95], v[110:111]
    v_pk_add_f32 v[96:97], v[96:97], v[112:113]
    v_pk_add_f32 v[98:99], v[98:99], v[114:115]
    v_pk_add_f32 v[100:101], v[100:101], v[116:117]
    v_pk_add_f32 v[102:103], v[102:103], v[118:119]
    v_pk_add_f32 v[104:105], v[104:105], v[120:121]
    v_pk_add_f32 v[106:107], v[106:107], v[122:123]
    v_mov_b32 v2, v104
    v_mov_b32 v3, v104
    s_nop 1
    v_permlane32_swap_b32 v2, v3
    v_rcp_f32 v4, v3
    v_cmp_le_f32 vcc, 0xd800000, v3
    s_nop 0
    s_mov_b64 s[6:7], vcc
    v_cmp_ge_f32 vcc, 0x5f800000, v3
    s_nop 0
    s_and_b64 s[6:7], s[6:7], vcc
    v_mov_b32 v5, v4
    v_pk_mul_f32 v[92:93], v[92:93], v[4:5]
    v_pk_mul_f32 v[94:95], v[94:95], v[4:5]
    v_pk_mul_f32 v[96:97], v[96:97], v[4:5]
    v_pk_mul_f32 v[98:99], v[98:99], v[4:5]
    v_pk_mul_f32 v[100:101], v[100:101], v[4:5]
    v_pk_mul_f32 v[102:103], v[102:103], v[4:5]
    v_pk_mul_f32 v[104:105], v[104:105], v[4:5]
    v_pk_mul_f32 v[106:107], v[106:107], v[4:5]
    v_cvt_pk_bf16_f32 v156, v92, v93
    v_cvt_pk_bf16_f32 v157, v94, v95
    v_cvt_pk_bf16_f32 v158, v96, v97
    v_cvt_pk_bf16_f32 v159, v98, v99
    v_cvt_pk_bf16_f32 v160, v100, v101
    v_cvt_pk_bf16_f32 v161, v102, v103
    v_cvt_pk_bf16_f32 v162, v104, v105
    v_cvt_pk_bf16_f32 v163, v106, v107
    s_mov_b64 exec, s[34:35]
    v_mov_b32 v162, 0
    v_mov_b32 v163, 0
    s_mov_b64 exec, -1
    buffer_store_dwordx4 v[156:159], v1, s[8:11], s65 offen offset:0 sc1
    buffer_store_dwordx4 v[160:163], v1, s[8:11], s65 offen offset:1024 sc1
    s_cmp_eq_u64 s[6:7], exec
    s_cbranch_scc1 concat_heads__linear_kernel_hedgehog__mha_block__prompt_kernel_fin_join
    v_mov_b32 v2, 153600
    v_mov_b32 v3, 1
    ds_write_b32 v2, v3 offset:4
    s_branch concat_heads__linear_kernel_hedgehog__mha_block__prompt_kernel_fin_join
concat_heads__linear_kernel_hedgehog__mha_block__prompt_kernel_fin_late_b:
    ds_write_b128 v164, v[92:95] offset:30976
    ds_write_b128 v164, v[96:99] offset:32000
    ds_write_b128 v164, v[100:103] offset:33024
    ds_write_b128 v164, v[104:107] offset:34048
    s_lshl_b32 s30, s38, 2
    s_lshl_b32 s31, s60, 1
    s_add_u32 s30, s30, s31
    s_add_u32 s30, s30, 1
    s_lshl_b32 s65, s30, 4
    s_add_u32 s65, s65, s37
    s_lshl_b32 s65, s65, 11
    s_add_u32 s65, s65, 14680064
    s_waitcnt lgkmcnt(0)
    s_barrier
    ds_read_b128 v[124:127], v164 offset:35072
    ds_read_b128 v[128:131], v164 offset:36096
    ds_read_b128 v[132:135], v164 offset:37120
    ds_read_b128 v[136:139], v164 offset:38144
    ds_read_b128 v[140:143], v164 offset:39168
    ds_read_b128 v[144:147], v164 offset:40192
    ds_read_b128 v[148:151], v164 offset:41216
    ds_read_b128 v[152:155], v164 offset:42240
    ds_read_b128 v[92:95], v164 offset:43264
    ds_read_b128 v[96:99], v164 offset:44288
    ds_read_b128 v[100:103], v164 offset:45312
    ds_read_b128 v[104:107], v164 offset:46336
    s_waitcnt lgkmcnt(8)
    v_pk_add_f32 v[108:109], v[108:109], v[124:125]
    v_pk_add_f32 v[110:111], v[110:111], v[126:127]
    v_pk_add_f32 v[112:113], v[112:113], v[128:129]
    v_pk_add_f32 v[114:115], v[114:115], v[130:131]
    v_pk_add_f32 v[116:117], v[116:117], v[132:133]
    v_pk_add_f32 v[118:119], v[118:119], v[134:135]
    v_pk_add_f32 v[120:121], v[120:121], v[136:137]
    v_pk_add_f32 v[122:123], v[122:123], v[138:139]
    s_waitcnt lgkmcnt(4)
    v_pk_add_f32 v[108:109], v[108:109], v[140:141]
    v_pk_add_f32 v[110:111], v[110:111], v[142:143]
    v_pk_add_f32 v[112:113], v[112:113], v[144:145]
    v_pk_add_f32 v[114:115], v[114:115], v[146:147]
    v_pk_add_f32 v[116:117], v[116:117], v[148:149]
    v_pk_add_f32 v[118:119], v[118:119], v[150:151]
    v_pk_add_f32 v[120:121], v[120:121], v[152:153]
    v_pk_add_f32 v[122:123], v[122:123], v[154:155]
    s_waitcnt lgkmcnt(0)
    v_pk_add_f32 v[108:109], v[108:109], v[92:93]
    v_pk_add_f32 v[110:111], v[110:111], v[94:95]
    v_pk_add_f32 v[112:113], v[112:113], v[96:97]
    v_pk_add_f32 v[114:115], v[114:115], v[98:99]
    v_pk_add_f32 v[116:117], v[116:117], v[100:101]
    v_pk_add_f32 v[118:119], v[118:119], v[102:103]
    v_pk_add_f32 v[120:121], v[120:121], v[104:105]
    v_pk_add_f32 v[122:123], v[122:123], v[106:107]
    v_mov_b32 v2, v120
    v_mov_b32 v3, v120
    s_nop 1
    v_permlane32_swap_b32 v2, v3
    v_rcp_f32 v4, v3
    v_cmp_le_f32 vcc, 0xd800000, v3
    s_nop 0
    s_mov_b64 s[6:7], vcc
    v_cmp_ge_f32 vcc, 0x5f800000, v3
    s_nop 0
    s_and_b64 s[6:7], s[6:7], vcc
    v_mov_b32 v5, v4
    v_pk_mul_f32 v[108:109], v[108:109], v[4:5]
    v_pk_mul_f32 v[110:111], v[110:111], v[4:5]
    v_pk_mul_f32 v[112:113], v[112:113], v[4:5]
    v_pk_mul_f32 v[114:115], v[114:115], v[4:5]
    v_pk_mul_f32 v[116:117], v[116:117], v[4:5]
    v_pk_mul_f32 v[118:119], v[118:119], v[4:5]
    v_pk_mul_f32 v[120:121], v[120:121], v[4:5]
    v_pk_mul_f32 v[122:123], v[122:123], v[4:5]
    v_cvt_pk_bf16_f32 v156, v108, v109
    v_cvt_pk_bf16_f32 v157, v110, v111
    v_cvt_pk_bf16_f32 v158, v112, v113
    v_cvt_pk_bf16_f32 v159, v114, v115
    v_cvt_pk_bf16_f32 v160, v116, v117
    v_cvt_pk_bf16_f32 v161, v118, v119
    v_cvt_pk_bf16_f32 v162, v120, v121
    v_cvt_pk_bf16_f32 v163, v122, v123
    s_mov_b64 exec, s[34:35]
    v_mov_b32 v162, 0
    v_mov_b32 v163, 0
    s_mov_b64 exec, -1
    buffer_store_dwordx4 v[156:159], v1, s[8:11], s65 offen offset:0 sc1
    buffer_store_dwordx4 v[160:163], v1, s[8:11], s65 offen offset:1024 sc1
    s_cmp_eq_u64 s[6:7], exec
    s_cbranch_scc1 concat_heads__linear_kernel_hedgehog__mha_block__prompt_kernel_fin_join
    v_mov_b32 v2, 153600
    v_mov_b32 v3, 1
    ds_write_b32 v2, v3 offset:4
    s_branch concat_heads__linear_kernel_hedgehog__mha_block__prompt_kernel_fin_join
concat_heads__linear_kernel_hedgehog__mha_block__prompt_kernel_fin_join:
    s_waitcnt vmcnt(0) lgkmcnt(0)
    s_barrier
    v_mov_b32 v2, 153600
    ds_read_b32 v3, v2 offset:4
    s_waitcnt lgkmcnt(0)
    v_readfirstlane_b32 s30, v3
    s_nop 0
    s_cmp_eq_u32 s30, 0
    s_nop 1
    s_cbranch_scc1 concat_heads__linear_kernel_hedgehog__mha_block__prompt_kernel_p2_done
    s_cmp_eq_u32 s66, 0
    s_cbranch_scc0 concat_heads__linear_kernel_hedgehog__mha_block__prompt_kernel_p2_done
    s_mov_b32 s66, 1
    s_mov_b64 exec, s[34:35]
    v_mov_b32 v18, 0
    v_mov_b32 v19, 0
    v_mov_b32 v26, 0
    v_mov_b32 v27, 0
    s_mov_b64 exec, -1
    v_mov_b32 v156, 0xff800000
    v_mov_b32 v157, 0xff800000
    s_mov_b32 s5, 0
    s_nop 0
concat_heads__linear_kernel_hedgehog__mha_block__prompt_kernel_ex_loop:
    s_lshl_b32 s30, s5, 11
    s_add_u32 s30, s30, s67
    buffer_load_dwordx4 v[52:55], v1, s[8:11], s30 offen
    buffer_load_dwordx4 v[56:59], v1, s[8:11], s30 offen offset:1024
    s_waitcnt vmcnt(0)
    v_mfma_f32_32x32x16_bf16 v[124:139], v[52:55], v[12:15], 0
    v_mfma_f32_32x32x16_bf16 v[124:139], v[56:59], v[16:19], v[124:139]
    v_mfma_f32_32x32x16_bf16 v[140:155], v[52:55], v[20:23], 0
    v_mfma_f32_32x32x16_bf16 v[140:155], v[56:59], v[24:27], v[140:155]
    s_nop 9
    v_max3_f32 v156, v156, v124, v125
    v_max3_f32 v156, v156, v126, v127
    v_max3_f32 v156, v156, v128, v129
    v_max3_f32 v156, v156, v130, v131
    v_max3_f32 v156, v156, v132, v133
    v_max3_f32 v156, v156, v134, v135
    v_max3_f32 v156, v156, v136, v137
    v_max3_f32 v156, v156, v138, v139
    v_max3_f32 v157, v157, v140, v141
    v_max3_f32 v157, v157, v142, v143
    v_max3_f32 v157, v157, v144, v145
    v_max3_f32 v157, v157, v146, v147
    v_max3_f32 v157, v157, v148, v149
    v_max3_f32 v157, v157, v150, v151
    v_max3_f32 v157, v157, v152, v153
    v_max3_f32 v157, v157, v154, v155
    s_add_u32 s5, s5, 1
    s_cmp_lt_u32 s5, 16
    s_cbranch_scc1 concat_heads__linear_kernel_hedgehog__mha_block__prompt_kernel_ex_loop
    v_mov_b32 v4, v156
    v_mov_b32 v5, v156
    s_nop 1
    v_permlane32_swap_b32 v4, v5
    v_max_f32 v156, v4, v5
    v_mov_b32 v4, v157
    v_mov_b32 v5, v157
    s_nop 1
    v_permlane32_swap_b32 v4, v5
    v_max_f32 v157, v4, v5
    s_lshl_b32 s30, s60, 10
    s_lshl_b32 s31, s61, 7
    v_and_b32 v2, 31, v0
    v_lshlrev_b32 v2, 2, v2
    v_add_u32 v2, s30, v2
    v_add_u32 v2, 153664, v2
    v_add_u32 v3, s31, v2
    ds_write_b32 v3, v156
    ds_write_b32 v3, v157 offset:512
    s_waitcnt lgkmcnt(0)
    s_barrier
    ds_read_b32 v124, v2 offset:0
    ds_read_b32 v125, v2 offset:128
    ds_read_b32 v126, v2 offset:256
    ds_read_b32 v127, v2 offset:384
    ds_read_b32 v128, v2 offset:512
    ds_read_b32 v129, v2 offset:640
    ds_read_b32 v130, v2 offset:768
    ds_read_b32 v131, v2 offset:896
    s_waitcnt lgkmcnt(0)
    v_max3_f32 v156, v124, v125, v126
    v_max_f32 v156, v156, v127
    v_max3_f32 v157, v128, v129, v130
    v_max_f32 v157, v157, v131
    v_xor_b32 v2, 0x80000000, v156
    v_and_b32 v3, 0xffff0000, v2
    v_sub_f32 v2, v2, v3
    v_and_b32 v4, 0xffff0000, v2
    v_sub_f32 v2, v2, v4
    v_lshrrev_b32 v3, 16, v3
    v_or_b32 v3, v3, v4
    v_lshrrev_b32 v2, 16, v2
    s_mov_b64 exec, s[34:35]
    v_mov_b32 v18, v3
    v_mov_b32 v19, v2
    s_mov_b64 exec, -1
    v_xor_b32 v2, 0x80000000, v157
    v_and_b32 v3, 0xffff0000, v2
    v_sub_f32 v2, v2, v3
    v_and_b32 v4, 0xffff0000, v2
    v_sub_f32 v2, v2, v4
    v_lshrrev_b32 v3, 16, v3
    v_or_b32 v3, v3, v4
    v_lshrrev_b32 v2, 16, v2
    s_mov_b64 exec, s[34:35]
    v_mov_b32 v26, v3
    v_mov_b32 v27, v2
    s_mov_b64 exec, -1
    v_mov_b32 v2, 153600
    v_mov_b32 v3, 0
    ds_write_b32 v2, v3 offset:4
    s_waitcnt lgkmcnt(0)
    s_barrier
    s_add_u32 s62, s67, 0
    s_add_u32 s63, s67, 2097152
    buffer_load_dwordx4 v[28:31], v1, s[8:11], s62 offen offset:0
    buffer_load_dwordx4 v[32:35], v1, s[8:11], s62 offen offset:1024
    buffer_load_dwordx4 v[60:63], v1, s[8:11], s63 offen offset:0
    buffer_load_dwordx4 v[64:67], v1, s[8:11], s63 offen offset:1024
    buffer_load_dwordx4 v[36:39], v1, s[8:11], s62 offen offset:2048
    buffer_load_dwordx4 v[40:43], v1, s[8:11], s62 offen offset:3072
    buffer_load_dwordx4 v[68:71], v1, s[8:11], s63 offen offset:2048
    buffer_load_dwordx4 v[72:75], v1, s[8:11], s63 offen offset:3072
    s_add_u32 s62, s67, 4096
    s_add_u32 s63, s67, 2101248
    buffer_load_dwordx4 v[44:47], v1, s[8:11], s62 offen offset:0
    buffer_load_dwordx4 v[48:51], v1, s[8:11], s62 offen offset:1024
    buffer_load_dwordx4 v[76:79], v1, s[8:11], s63 offen offset:0
    buffer_load_dwordx4 v[80:83], v1, s[8:11], s63 offen offset:1024
    s_waitcnt vmcnt(0)
    s_branch concat_heads__linear_kernel_hedgehog__mha_block__prompt_kernel_att_go
concat_heads__linear_kernel_hedgehog__mha_block__prompt_kernel_p2_done:
    s_cmp_lt_u32 s26, 4
    s_cbranch_scc0 concat_heads__linear_kernel_hedgehog__mha_block__prompt_kernel_exit
    s_cmp_eq_u32 s26, 0
    s_cbranch_scc0 concat_heads__linear_kernel_hedgehog__mha_block__prompt_kernel_p3_go
    s_lshl_b32 s30, s38, 4
    s_add_u32 s30, s30, s37
    s_lshl_b32 s30, s30, 7
    s_add_u32 s30, s30, 19529728
    v_mov_b32 v2, 0
    v_mov_b32 v3, 1
    s_mov_b64 exec, 1
    buffer_store_dword v3, v2, s[8:11], s30 offen sc1
    s_mov_b64 exec, -1
concat_heads__linear_kernel_hedgehog__mha_block__prompt_kernel_p3_go:
    s_cmp_lt_u32 s25, 28
    s_cbranch_scc0 concat_heads__linear_kernel_hedgehog__mha_block__prompt_kernel_exit
    s_setprio 0
    s_mov_b32 s12, s54
    s_mov_b32 s13, s55
    s_mov_b32 s14, 3670016
    s_mov_b32 s15, 0x00020000
    v_lshlrev_b32 v4, 4, v0
    s_lshl_b32 s30, s28, 2
    s_add_u32 s30, s30, s26
    s_lshl_b32 s62, s30, 15
    s_mul_i32 s31, s27, 2097152
    s_add_u32 s62, s62, s31
    s_add_u32 s62, s62, 12582912
    s_mul_i32 s30, s30, 57344
    s_mul_i32 s31, s27, 896
    s_add_u32 s30, s30, s31
    s_lshl_b32 s31, s29, 7
    s_add_u32 s63, s30, s31
    v_and_b32 v1, 31, v0
    v_mul_u32_u24 v1, 1792, v1
    v_lshrrev_b32 v2, 5, v0
    v_lshl_add_u32 v5, v2, 4, v1
    v_lshrrev_b32 v1, 5, v0
    v_lshlrev_b32 v1, 2, v1
    v_bfe_u32 v2, v0, 2, 2
    v_add_u32 v1, v1, v2
    v_lshlrev_b32 v1, 7, v1
    v_bfe_u32 v2, v0, 4, 1
    v_lshl_add_u32 v1, v2, 5, v1
    v_and_b32 v3, 3, v0
    v_lshl_add_u32 v1, v3, 3, v1
    v_add_u32 v1, 81920, v1
    v_bfe_u32 v2, v0, 3, 1
    v_lshl_add_u32 v6, v2, 6, v1
    v_xor_b32 v2, 1, v2
    v_lshl_add_u32 v7, v2, 6, v1
    s_lshl_b32 s30, s28, 11
    s_add_u32 s30, s30, 19529728
    v_and_b32 v1, 15, v0
    v_lshlrev_b32 v1, 7, v1
    v_add_u32 v1, s30, v1
    v_mov_b32 v2, 1
    s_mov_b32 s36, 0
    s_nop 0
concat_heads__linear_kernel_hedgehog__mha_block__prompt_kernel_s2p:
    buffer_load_dword v3, v1, s[8:11], 0 offen sc1
    s_add_u32 s36, s36, 1
    s_waitcnt vmcnt(0)
    v_cmp_ge_u32 vcc, v3, v2
    s_nop 0
    s_cmp_eq_u64 vcc, exec
    s_nop 1
    s_cbranch_scc1 concat_heads__linear_kernel_hedgehog__mha_block__prompt_kernel_s2p_ok
    s_cmp_ge_u32 s36, 400000
    s_cbranch_scc1 concat_heads__linear_kernel_hedgehog__mha_block__prompt_kernel_s2p_ok
    s_sleep 1
    s_branch concat_heads__linear_kernel_hedgehog__mha_block__prompt_kernel_s2p
concat_heads__linear_kernel_hedgehog__mha_block__prompt_kernel_s2p_ok:
    s_add_u32 s30, s62, 0
    buffer_load_dwordx4 v[12:15], v4, s[8:11], s30 offen offset:0
    buffer_load_dwordx4 v[16:19], v4, s[8:11], s30 offen offset:1024
    buffer_load_dwordx4 v[20:23], v4, s[8:11], s30 offen offset:2048
    buffer_load_dwordx4 v[24:27], v4, s[8:11], s30 offen offset:3072
    s_add_u32 s30, s62, 4096
    buffer_load_dwordx4 v[28:31], v4, s[8:11], s30 offen offset:0
    buffer_load_dwordx4 v[32:35], v4, s[8:11], s30 offen offset:1024
    buffer_load_dwordx4 v[36:39], v4, s[8:11], s30 offen offset:2048
    buffer_load_dwordx4 v[40:43], v4, s[8:11], s30 offen offset:3072
    s_add_u32 s30, s62, 8192
    buffer_load_dwordx4 v[44:47], v4, s[8:11], s30 offen offset:0
    buffer_load_dwordx4 v[48:51], v4, s[8:11], s30 offen offset:1024
    buffer_load_dwordx4 v[52:55], v4, s[8:11], s30 offen offset:2048
    buffer_load_dwordx4 v[56:59], v4, s[8:11], s30 offen offset:3072
    s_add_u32 s30, s62, 12288
    buffer_load_dwordx4 v[60:63], v4, s[8:11], s30 offen offset:0
    buffer_load_dwordx4 v[64:67], v4, s[8:11], s30 offen offset:1024
    buffer_load_dwordx4 v[68:71], v4, s[8:11], s30 offen offset:2048
    buffer_load_dwordx4 v[72:75], v4, s[8:11], s30 offen offset:3072
    s_add_u32 s30, s62, 16384
    buffer_load_dwordx4 v[76:79], v4, s[8:11], s30 offen offset:0
    buffer_load_dwordx4 v[80:83], v4, s[8:11], s30 offen offset:1024
    buffer_load_dwordx4 v[84:87], v4, s[8:11], s30 offen offset:2048
    buffer_load_dwordx4 v[88:91], v4, s[8:11], s30 offen offset:3072
    s_add_u32 s30, s62, 20480
    buffer_load_dwordx4 v[92:95], v4, s[8:11], s30 offen offset:0
    buffer_load_dwordx4 v[96:99], v4, s[8:11], s30 offen offset:1024
    buffer_load_dwordx4 v[100:103], v4, s[8:11], s30 offen offset:2048
    buffer_load_dwordx4 v[104:107], v4, s[8:11], s30 offen offset:3072
    s_add_u32 s30, s62, 24576
    buffer_load_dwordx4 v[108:111], v4, s[8:11], s30 offen offset:0
    buffer_load_dwordx4 v[112:115], v4, s[8:11], s30 offen offset:1024
    buffer_load_dwordx4 v[116:119], v4, s[8:11], s30 offen offset:2048
    buffer_load_dwordx4 v[120:123], v4, s[8:11], s30 offen offset:3072
    s_add_u32 s30, s62, 28672
    buffer_load_dwordx4 v[124:127], v4, s[8:11], s30 offen offset:0
    buffer_load_dwordx4 v[128:131], v4, s[8:11], s30 offen offset:1024
    buffer_load_dwordx4 v[132:135], v4, s[8:11], s30 offen offset:2048
    buffer_load_dwordx4 v[136:139], v4, s[8:11], s30 offen offset:3072
    ds_read_b64_tr_b16 v[172:173], v6 offset:0
    ds_read_b64_tr_b16 v[174:175], v6 offset:1024
    ds_read_b64_tr_b16 v[176:177], v7 offset:0
    ds_read_b64_tr_b16 v[178:179], v7 offset:1024
    s_waitcnt lgkmcnt(0)
    ds_read_b64_tr_b16 v[180:181], v6 offset:2048
    ds_read_b64_tr_b16 v[182:183], v6 offset:3072
    ds_read_b64_tr_b16 v[184:185], v7 offset:2048
    ds_read_b64_tr_b16 v[186:187], v7 offset:3072
    s_waitcnt vmcnt(31)
    v_mfma_f32_32x32x16_bf16 v[140:155], v[172:175], v[12:15], 0
    v_mfma_f32_32x32x16_bf16 v[156:171], v[176:179], v[12:15], 0
    s_waitcnt lgkmcnt(0)
    ds_read_b64_tr_b16 v[172:173], v6 offset:3584
    ds_read_b64_tr_b16 v[174:175], v6 offset:4608
    ds_read_b64_tr_b16 v[176:177], v7 offset:3584
    ds_read_b64_tr_b16 v[178:179], v7 offset:4608
    s_waitcnt vmcnt(30)
    v_mfma_f32_32x32x16_bf16 v[140:155], v[180:183], v[16:19], v[140:155]
    v_mfma_f32_32x32x16_bf16 v[156:171], v[184:187], v[16:19], v[156:171]
    s_waitcnt lgkmcnt(0)
    ds_read_b64_tr_b16 v[180:181], v6 offset:5632
    ds_read_b64_tr_b16 v[182:183], v6 offset:6656
    ds_read_b64_tr_b16 v[184:185], v7 offset:5632
    ds_read_b64_tr_b16 v[186:187], v7 offset:6656
    s_waitcnt vmcnt(29)
    v_mfma_f32_32x32x16_bf16 v[140:155], v[172:175], v[20:23], v[140:155]
    v_mfma_f32_32x32x16_bf16 v[156:171], v[176:179], v[20:23], v[156:171]
    s_waitcnt lgkmcnt(0)
    ds_read_b64_tr_b16 v[172:173], v6 offset:7168
    ds_read_b64_tr_b16 v[174:175], v6 offset:8192
    ds_read_b64_tr_b16 v[176:177], v7 offset:7168
    ds_read_b64_tr_b16 v[178:179], v7 offset:8192
    s_waitcnt vmcnt(28)
    v_mfma_f32_32x32x16_bf16 v[140:155], v[180:183], v[24:27], v[140:155]
    v_mfma_f32_32x32x16_bf16 v[156:171], v[184:187], v[24:27], v[156:171]
    s_waitcnt lgkmcnt(0)
    ds_read_b64_tr_b16 v[180:181], v6 offset:9216
    ds_read_b64_tr_b16 v[182:183], v6 offset:10240
    ds_read_b64_tr_b16 v[184:185], v7 offset:9216
    ds_read_b64_tr_b16 v[186:187], v7 offset:10240
    s_waitcnt vmcnt(27)
    v_mfma_f32_32x32x16_bf16 v[140:155], v[172:175], v[28:31], v[140:155]
    v_mfma_f32_32x32x16_bf16 v[156:171], v[176:179], v[28:31], v[156:171]
    s_waitcnt lgkmcnt(0)
    ds_read_b64_tr_b16 v[172:173], v6 offset:10752
    ds_read_b64_tr_b16 v[174:175], v6 offset:11776
    ds_read_b64_tr_b16 v[176:177], v7 offset:10752
    ds_read_b64_tr_b16 v[178:179], v7 offset:11776
    s_waitcnt vmcnt(26)
    v_mfma_f32_32x32x16_bf16 v[140:155], v[180:183], v[32:35], v[140:155]
    v_mfma_f32_32x32x16_bf16 v[156:171], v[184:187], v[32:35], v[156:171]
    s_waitcnt lgkmcnt(0)
    ds_read_b64_tr_b16 v[180:181], v6 offset:12800
    ds_read_b64_tr_b16 v[182:183], v6 offset:13824
    ds_read_b64_tr_b16 v[184:185], v7 offset:12800
    ds_read_b64_tr_b16 v[186:187], v7 offset:13824
    s_waitcnt vmcnt(25)
    v_mfma_f32_32x32x16_bf16 v[140:155], v[172:175], v[36:39], v[140:155]
    v_mfma_f32_32x32x16_bf16 v[156:171], v[176:179], v[36:39], v[156:171]
    s_waitcnt lgkmcnt(0)
    ds_read_b64_tr_b16 v[172:173], v6 offset:14336
    ds_read_b64_tr_b16 v[174:175], v6 offset:15360
    ds_read_b64_tr_b16 v[176:177], v7 offset:14336
    ds_read_b64_tr_b16 v[178:179], v7 offset:15360
    s_waitcnt vmcnt(24)
    v_mfma_f32_32x32x16_bf16 v[140:155], v[180:183], v[40:43], v[140:155]
    v_mfma_f32_32x32x16_bf16 v[156:171], v[184:187], v[40:43], v[156:171]
    s_waitcnt lgkmcnt(0)
    ds_read_b64_tr_b16 v[180:181], v6 offset:16384
    ds_read_b64_tr_b16 v[182:183], v6 offset:17408
    ds_read_b64_tr_b16 v[184:185], v7 offset:16384
    ds_read_b64_tr_b16 v[186:187], v7 offset:17408
    s_waitcnt vmcnt(23)
    v_mfma_f32_32x32x16_bf16 v[140:155], v[172:175], v[44:47], v[140:155]
    v_mfma_f32_32x32x16_bf16 v[156:171], v[176:179], v[44:47], v[156:171]
    s_waitcnt lgkmcnt(0)
    ds_read_b64_tr_b16 v[172:173], v6 offset:17920
    ds_read_b64_tr_b16 v[174:175], v6 offset:18944
    ds_read_b64_tr_b16 v[176:177], v7 offset:17920
    ds_read_b64_tr_b16 v[178:179], v7 offset:18944
    s_waitcnt vmcnt(22)
    v_mfma_f32_32x32x16_bf16 v[140:155], v[180:183], v[48:51], v[140:155]
    v_mfma_f32_32x32x16_bf16 v[156:171], v[184:187], v[48:51], v[156:171]
    s_waitcnt lgkmcnt(0)
    ds_read_b64_tr_b16 v[180:181], v6 offset:19968
    ds_read_b64_tr_b16 v[182:183], v6 offset:20992
    ds_read_b64_tr_b16 v[184:185], v7 offset:19968
    ds_read_b64_tr_b16 v[186:187], v7 offset:20992
    s_waitcnt vmcnt(21)
    v_mfma_f32_32x32x16_bf16 v[140:155], v[172:175], v[52:55], v[140:155]
    v_mfma_f32_32x32x16_bf16 v[156:171], v[176:179], v[52:55], v[156:171]
    s_waitcnt lgkmcnt(0)
    ds_read_b64_tr_b16 v[172:173], v6 offset:21504
    ds_read_b64_tr_b16 v[174:175], v6 offset:22528
    ds_read_b64_tr_b16 v[176:177], v7 offset:21504
    ds_read_b64_tr_b16 v[178:179], v7 offset:22528
    s_waitcnt vmcnt(20)
    v_mfma_f32_32x32x16_bf16 v[140:155], v[180:183], v[56:59], v[140:155]
    v_mfma_f32_32x32x16_bf16 v[156:171], v[184:187], v[56:59], v[156:171]
    s_waitcnt lgkmcnt(0)
    ds_read_b64_tr_b16 v[180:181], v6 offset:23552
    ds_read_b64_tr_b16 v[182:183], v6 offset:24576
    ds_read_b64_tr_b16 v[184:185], v7 offset:23552
    ds_read_b64_tr_b16 v[186:187], v7 offset:24576
    s_waitcnt vmcnt(19)
    v_mfma_f32_32x32x16_bf16 v[140:155], v[172:175], v[60:63], v[140:155]
    v_mfma_f32_32x32x16_bf16 v[156:171], v[176:179], v[60:63], v[156:171]
    s_waitcnt lgkmcnt(0)
    ds_read_b64_tr_b16 v[172:173], v6 offset:25088
    ds_read_b64_tr_b16 v[174:175], v6 offset:26112
    ds_read_b64_tr_b16 v[176:177], v7 offset:25088
    ds_read_b64_tr_b16 v[178:179], v7 offset:26112
    s_waitcnt vmcnt(18)
    v_mfma_f32_32x32x16_bf16 v[140:155], v[180:183], v[64:67], v[140:155]
    v_mfma_f32_32x32x16_bf16 v[156:171], v[184:187], v[64:67], v[156:171]
    s_waitcnt lgkmcnt(0)
    ds_read_b64_tr_b16 v[180:181], v6 offset:27136
    ds_read_b64_tr_b16 v[182:183], v6 offset:28160
    ds_read_b64_tr_b16 v[184:185], v7 offset:27136
    ds_read_b64_tr_b16 v[186:187], v7 offset:28160
    s_waitcnt vmcnt(17)
    v_mfma_f32_32x32x16_bf16 v[140:155], v[172:175], v[68:71], v[140:155]
    v_mfma_f32_32x32x16_bf16 v[156:171], v[176:179], v[68:71], v[156:171]
    s_waitcnt lgkmcnt(0)
    ds_read_b64_tr_b16 v[172:173], v6 offset:28672
    ds_read_b64_tr_b16 v[174:175], v6 offset:29696
    ds_read_b64_tr_b16 v[176:177], v7 offset:28672
    ds_read_b64_tr_b16 v[178:179], v7 offset:29696
    s_waitcnt vmcnt(16)
    v_mfma_f32_32x32x16_bf16 v[140:155], v[180:183], v[72:75], v[140:155]
    v_mfma_f32_32x32x16_bf16 v[156:171], v[184:187], v[72:75], v[156:171]
    s_waitcnt lgkmcnt(0)
    ds_read_b64_tr_b16 v[180:181], v6 offset:30720
    ds_read_b64_tr_b16 v[182:183], v6 offset:31744
    ds_read_b64_tr_b16 v[184:185], v7 offset:30720
    ds_read_b64_tr_b16 v[186:187], v7 offset:31744
    s_waitcnt vmcnt(15)
    v_mfma_f32_32x32x16_bf16 v[140:155], v[172:175], v[76:79], v[140:155]
    v_mfma_f32_32x32x16_bf16 v[156:171], v[176:179], v[76:79], v[156:171]
    s_waitcnt lgkmcnt(0)
    ds_read_b64_tr_b16 v[172:173], v6 offset:32256
    ds_read_b64_tr_b16 v[174:175], v6 offset:33280
    ds_read_b64_tr_b16 v[176:177], v7 offset:32256
    ds_read_b64_tr_b16 v[178:179], v7 offset:33280
    s_waitcnt vmcnt(14)
    v_mfma_f32_32x32x16_bf16 v[140:155], v[180:183], v[80:83], v[140:155]
    v_mfma_f32_32x32x16_bf16 v[156:171], v[184:187], v[80:83], v[156:171]
    s_waitcnt lgkmcnt(0)
    ds_read_b64_tr_b16 v[180:181], v6 offset:34304
    ds_read_b64_tr_b16 v[182:183], v6 offset:35328
    ds_read_b64_tr_b16 v[184:185], v7 offset:34304
    ds_read_b64_tr_b16 v[186:187], v7 offset:35328
    s_waitcnt vmcnt(13)
    v_mfma_f32_32x32x16_bf16 v[140:155], v[172:175], v[84:87], v[140:155]
    v_mfma_f32_32x32x16_bf16 v[156:171], v[176:179], v[84:87], v[156:171]
    s_waitcnt lgkmcnt(0)
    ds_read_b64_tr_b16 v[172:173], v6 offset:35840
    ds_read_b64_tr_b16 v[174:175], v6 offset:36864
    ds_read_b64_tr_b16 v[176:177], v7 offset:35840
    ds_read_b64_tr_b16 v[178:179], v7 offset:36864
    s_waitcnt vmcnt(12)
    v_mfma_f32_32x32x16_bf16 v[140:155], v[180:183], v[88:91], v[140:155]
    v_mfma_f32_32x32x16_bf16 v[156:171], v[184:187], v[88:91], v[156:171]
    s_waitcnt lgkmcnt(0)
    ds_read_b64_tr_b16 v[180:181], v6 offset:37888
    ds_read_b64_tr_b16 v[182:183], v6 offset:38912
    ds_read_b64_tr_b16 v[184:185], v7 offset:37888
    ds_read_b64_tr_b16 v[186:187], v7 offset:38912
    s_waitcnt vmcnt(11)
    v_mfma_f32_32x32x16_bf16 v[140:155], v[172:175], v[92:95], v[140:155]
    v_mfma_f32_32x32x16_bf16 v[156:171], v[176:179], v[92:95], v[156:171]
    s_waitcnt lgkmcnt(0)
    ds_read_b64_tr_b16 v[172:173], v6 offset:39424
    ds_read_b64_tr_b16 v[174:175], v6 offset:40448
    ds_read_b64_tr_b16 v[176:177], v7 offset:39424
    ds_read_b64_tr_b16 v[178:179], v7 offset:40448
    s_waitcnt vmcnt(10)
    v_mfma_f32_32x32x16_bf16 v[140:155], v[180:183], v[96:99], v[140:155]
    v_mfma_f32_32x32x16_bf16 v[156:171], v[184:187], v[96:99], v[156:171]
    s_waitcnt lgkmcnt(0)
    ds_read_b64_tr_b16 v[180:181], v6 offset:41472
    ds_read_b64_tr_b16 v[182:183], v6 offset:42496
    ds_read_b64_tr_b16 v[184:185], v7 offset:41472
    ds_read_b64_tr_b16 v[186:187], v7 offset:42496
    s_waitcnt vmcnt(9)
    v_mfma_f32_32x32x16_bf16 v[140:155], v[172:175], v[100:103], v[140:155]
    v_mfma_f32_32x32x16_bf16 v[156:171], v[176:179], v[100:103], v[156:171]
    s_waitcnt lgkmcnt(0)
    ds_read_b64_tr_b16 v[172:173], v6 offset:43008
    ds_read_b64_tr_b16 v[174:175], v6 offset:44032
    ds_read_b64_tr_b16 v[176:177], v7 offset:43008
    ds_read_b64_tr_b16 v[178:179], v7 offset:44032
    s_waitcnt vmcnt(8)
    v_mfma_f32_32x32x16_bf16 v[140:155], v[180:183], v[104:107], v[140:155]
    v_mfma_f32_32x32x16_bf16 v[156:171], v[184:187], v[104:107], v[156:171]
    s_waitcnt lgkmcnt(0)
    ds_read_b64_tr_b16 v[180:181], v6 offset:45056
    ds_read_b64_tr_b16 v[182:183], v6 offset:46080
    ds_read_b64_tr_b16 v[184:185], v7 offset:45056
    ds_read_b64_tr_b16 v[186:187], v7 offset:46080
    s_waitcnt vmcnt(7)
    v_mfma_f32_32x32x16_bf16 v[140:155], v[172:175], v[108:111], v[140:155]
    v_mfma_f32_32x32x16_bf16 v[156:171], v[176:179], v[108:111], v[156:171]
    s_waitcnt lgkmcnt(0)
    ds_read_b64_tr_b16 v[172:173], v6 offset:46592
    ds_read_b64_tr_b16 v[174:175], v6 offset:47616
    ds_read_b64_tr_b16 v[176:177], v7 offset:46592
    ds_read_b64_tr_b16 v[178:179], v7 offset:47616
    s_waitcnt vmcnt(6)
    v_mfma_f32_32x32x16_bf16 v[140:155], v[180:183], v[112:115], v[140:155]
    v_mfma_f32_32x32x16_bf16 v[156:171], v[184:187], v[112:115], v[156:171]
    s_waitcnt lgkmcnt(0)
    ds_read_b64_tr_b16 v[180:181], v6 offset:48640
    ds_read_b64_tr_b16 v[182:183], v6 offset:49664
    ds_read_b64_tr_b16 v[184:185], v7 offset:48640
    ds_read_b64_tr_b16 v[186:187], v7 offset:49664
    s_waitcnt vmcnt(5)
    v_mfma_f32_32x32x16_bf16 v[140:155], v[172:175], v[116:119], v[140:155]
    v_mfma_f32_32x32x16_bf16 v[156:171], v[176:179], v[116:119], v[156:171]
    s_waitcnt lgkmcnt(0)
    ds_read_b64_tr_b16 v[172:173], v6 offset:50176
    ds_read_b64_tr_b16 v[174:175], v6 offset:51200
    ds_read_b64_tr_b16 v[176:177], v7 offset:50176
    ds_read_b64_tr_b16 v[178:179], v7 offset:51200
    s_waitcnt vmcnt(4)
    v_mfma_f32_32x32x16_bf16 v[140:155], v[180:183], v[120:123], v[140:155]
    v_mfma_f32_32x32x16_bf16 v[156:171], v[184:187], v[120:123], v[156:171]
    s_waitcnt lgkmcnt(0)
    ds_read_b64_tr_b16 v[180:181], v6 offset:52224
    ds_read_b64_tr_b16 v[182:183], v6 offset:53248
    ds_read_b64_tr_b16 v[184:185], v7 offset:52224
    ds_read_b64_tr_b16 v[186:187], v7 offset:53248
    s_waitcnt vmcnt(3)
    v_mfma_f32_32x32x16_bf16 v[140:155], v[172:175], v[124:127], v[140:155]
    v_mfma_f32_32x32x16_bf16 v[156:171], v[176:179], v[124:127], v[156:171]
    s_waitcnt lgkmcnt(0)
    ds_read_b64_tr_b16 v[172:173], v6 offset:53760
    ds_read_b64_tr_b16 v[174:175], v6 offset:54784
    ds_read_b64_tr_b16 v[176:177], v7 offset:53760
    ds_read_b64_tr_b16 v[178:179], v7 offset:54784
    s_waitcnt vmcnt(2)
    v_mfma_f32_32x32x16_bf16 v[140:155], v[180:183], v[128:131], v[140:155]
    v_mfma_f32_32x32x16_bf16 v[156:171], v[184:187], v[128:131], v[156:171]
    s_waitcnt lgkmcnt(0)
    ds_read_b64_tr_b16 v[180:181], v6 offset:55808
    ds_read_b64_tr_b16 v[182:183], v6 offset:56832
    ds_read_b64_tr_b16 v[184:185], v7 offset:55808
    ds_read_b64_tr_b16 v[186:187], v7 offset:56832
    s_waitcnt vmcnt(1)
    v_mfma_f32_32x32x16_bf16 v[140:155], v[172:175], v[132:135], v[140:155]
    v_mfma_f32_32x32x16_bf16 v[156:171], v[176:179], v[132:135], v[156:171]
    s_waitcnt lgkmcnt(0)
    s_waitcnt vmcnt(0)
    v_mfma_f32_32x32x16_bf16 v[140:155], v[180:183], v[136:139], v[140:155]
    v_mfma_f32_32x32x16_bf16 v[156:171], v[184:187], v[136:139], v[156:171]
    s_nop 10
    v_cvt_pk_bf16_f32 v188, v140, v141
    v_cvt_pk_bf16_f32 v189, v142, v143
    v_cvt_pk_bf16_f32 v190, v144, v145
    v_cvt_pk_bf16_f32 v191, v146, v147
    v_cvt_pk_bf16_f32 v192, v148, v149
    v_cvt_pk_bf16_f32 v193, v150, v151
    v_cvt_pk_bf16_f32 v194, v152, v153
    v_cvt_pk_bf16_f32 v195, v154, v155
    v_permlane32_swap_b32 v188, v190
    v_permlane32_swap_b32 v189, v191
    v_permlane32_swap_b32 v192, v194
    v_permlane32_swap_b32 v193, v195
    buffer_store_dwordx4 v[188:191], v5, s[12:15], s63 offen offset:0
    buffer_store_dwordx4 v[192:195], v5, s[12:15], s63 offen offset:32
    s_nop 0
    v_cvt_pk_bf16_f32 v188, v156, v157
    v_cvt_pk_bf16_f32 v189, v158, v159
    v_cvt_pk_bf16_f32 v190, v160, v161
    v_cvt_pk_bf16_f32 v191, v162, v163
    v_cvt_pk_bf16_f32 v192, v164, v165
    v_cvt_pk_bf16_f32 v193, v166, v167
    v_cvt_pk_bf16_f32 v194, v168, v169
    v_cvt_pk_bf16_f32 v195, v170, v171
    v_permlane32_swap_b32 v188, v190
    v_permlane32_swap_b32 v189, v191
    v_permlane32_swap_b32 v192, v194
    v_permlane32_swap_b32 v193, v195
    buffer_store_dwordx4 v[188:191], v5, s[12:15], s63 offen offset:64
    buffer_store_dwordx4 v[192:195], v5, s[12:15], s63 offen offset:96
    s_nop 1
concat_heads__linear_kernel_hedgehog__mha_block__prompt_kernel_exit:
concat_heads__linear_kernel_hedgehog__mha_block__prompt_kernel_end:
    s_endpgm
.section .rodata,"a"
.p2align 6
.amdhsa_kernel concat_heads__linear_kernel_hedgehog__mha_block__prompt_kernel
  .amdhsa_next_free_vgpr 232
  .amdhsa_next_free_sgpr 102
  .amdhsa_accum_offset 232
  .amdhsa_group_segment_fixed_size 0
  .amdhsa_kernarg_size 80
  .amdhsa_user_sgpr_count 2
  .amdhsa_user_sgpr_kernarg_segment_ptr 1
  .amdhsa_system_sgpr_workgroup_id_x 1
  .amdhsa_float_denorm_mode_32 3
.end_amdhsa_kernel
```
